```python
import torch

def _softmax(x, axis=-1):
    return torch.softmax(x, dim=axis)

def _gelu(x):
    return torch.nn.functional.gelu(x, approximate='tanh')

def _silu(x):
    return torch.nn.functional.silu(x)

def _sigmoid(x):
    return torch.sigmoid(x)

def _layernorm(x, axis=-1, eps=1e-05):
    m = x.mean(dim=axis, keepdim=True)
    v = x.var(dim=axis, keepdim=True, unbiased=False)
    return (x - m) / torch.sqrt(v + eps)

def _scatter_add(tgt, idx, src, axis=0):
    return tgt.clone().index_add_(axis, idx, src)

def _segment_sum(src, seg, n):
    out = torch.zeros((n,) + src.shape[1:], dtype=src.dtype)
    return out.index_add_(0, seg, src)

def _pad(x, pw):
    flat = tuple((v for pair in reversed(pw) for v in pair))
    return torch.nn.functional.pad(x, flat)
kernel_name = 'standalone__autoregressive_conv_wavenet__speech'

def setup_inputs():

    _w = lambda a: (lambda t: t.to(torch.bfloat16) if t.is_floating_point() else t)(torch.as_tensor(a))
    B, T, D, K = (2, 1000, 512, 31)
    return {'x': _w((lambda *s: torch.randn(*s, dtype=torch.bfloat16) * 0.05)(B, T, D)), 'w': _w((lambda *s: torch.randn(*s, dtype=torch.bfloat16) * 0.05)(K, D, 2 * D)), 'w_o': _w((lambda *s: torch.randn(*s, dtype=torch.bfloat16) * 0.05)(D, D))}

def reference(x, w, w_o):
    B, T, D = x.shape
    K = w.shape[0]
    dil = 2
    pad = (K - 1) * dil
    xp = _pad(x, ((0, 0), (pad, 0), (0, 0)))
    h = torch.einsum('btc,cd->btd', xp[:, pad:pad + T, :], w[0])
    for i in range(1, K):
        off = pad - i * dil
        h = h + torch.einsum('btc,cd->btd', xp[:, off:off + T, :], w[i])
    f = h[..., :D].clone()
    g = h[..., D:].clone()
    z = torch.tanh(f) * _sigmoid(g)
    return z @ w_o
```

```asm
; @launch grid=(256,1,1) block=(256,1,1) lds=163840
.amdgcn_target "amdgcn-amd-amdhsa--gfx950"
.text
.globl standalone__autoregressive_conv_wavenet__speech_kernel
.p2align 8
.type standalone__autoregressive_conv_wavenet__speech_kernel,@function
standalone__autoregressive_conv_wavenet__speech_kernel:

    s_cmp_ge_u32 s2, 256
    s_cbranch_scc1 Lend
    s_load_dwordx8 s[4:11], s[0:1], 0
    s_load_dwordx4 s[12:15], s[0:1], 32
    s_getpc_b64 s[62:63]
Lpc:
    s_and_b32 s41, s2, 7
    s_lshr_b32 s42, s2, 3
    s_lshl_b32 s59, s42, 10
    s_add_u32 s59, s59, 0
    v_lshrrev_b32 v120, 6, v0
    v_and_b32 v121, 1, v0
    v_lshlrev_b32 v120, 8, v120
    v_lshl_add_u32 v120, v121, 7, v120
    v_add_u32 v120, s59, v120
    v_min_u32 v120, Lend-Lpc, v120
    v_mov_b32 v123, s63
    v_add_co_u32 v122, vcc, s62, v120
    s_nop 1
    v_addc_co_u32 v123, vcc, 0, v123, vcc
    global_load_dword v121, v[122:123], off
    v_lshrrev_b32 v2, 6, v0
    v_and_b32 v1, 63, v0
    v_readfirstlane_b32 s40, v2
    s_and_b32 s43, s41, 3
    s_lshr_b32 s44, s41, 2
    s_and_b32 s45, s42, 3
    s_lshr_b32 s46, s42, 2
    s_lshl_b32 s59, s44, 3
    s_add_u32 s46, s46, s59
    v_lshrrev_b32 v2, 3, v1
    v_and_b32 v3, 7, v1
    v_and_b32 v4, 2, v2
    v_xor_b32 v3, v3, v4
    s_lshl_b32 s52, s40, 3
    v_add_u32 v2, s52, v2
    v_lshlrev_b32 v2, 20, v2
    v_lshl_add_u32 v2, v3, 4, v2
    v_xor_b32 v3, 64, v2
    s_lshl_b32 s52, s43, 18
    s_lshl_b32 s53, s46, 7
    s_add_u32 s52, s52, s53
    s_lshr_b32 s47, s40, 1
    s_lshl_b32 s47, s47, 14
    s_and_b32 s53, s40, 1
    s_lshl_b32 s53, s53, 10
    s_add_u32 s47, s47, s53
    s_add_u32 s53, s45, 0
    s_and_b32 s53, s53, 3
    s_lshl_b32 s53, s53, 14
    s_add_u32 s48, s52, s53
    s_add_u32 s53, s45, 1
    s_and_b32 s53, s53, 3
    s_lshl_b32 s53, s53, 14
    s_add_u32 s49, s52, s53
    s_add_u32 s53, s45, 2
    s_and_b32 s53, s53, 3
    s_lshl_b32 s53, s53, 14
    s_add_u32 s50, s52, s53
    s_add_u32 s53, s45, 3
    s_and_b32 s53, s53, 3
    s_lshl_b32 s53, s53, 14
    s_add_u32 s51, s52, s53
    s_lshr_b32 s94, s42, 4
    s_lshl_b32 s94, s94, 3
    s_and_b32 s52, s42, 7
    s_add_u32 s94, s94, s52
    s_lshl_b32 s94, s94, 1
    s_and_b32 s52, s94, 7
    s_lshl_b32 s52, s52, 7
    s_bfe_u32 s53, s94, 0x10003
    s_add_u32 s52, s52, s53
    s_mul_i32 s53, s40, 80
    s_add_u32 s52, s52, s53
    s_sub_u32 s52, s52, 64
    s_lshl_b32 s52, s52, 10
    s_lshl_b32 s53, s43, 8
    s_add_u32 s52, s52, s53
    s_lshl_b32 s53, s44, 7
    s_add_u32 s52, s52, s53
    v_lshrrev_b32 v250, 3, v1
    v_and_b32 v251, 7, v1
    v_lshlrev_b32 v250, 11, v250
    v_lshl_add_u32 v250, v251, 4, v250
    v_add_u32 v250, s52, v250
    s_lshr_b32 s53, s94, 4
    s_mul_i32 s100, s53, 1024000
    s_mul_i32 s59, s40, 5120
    s_lshl_b32 s96, s43, 18
    s_lshl_b32 s53, s44, 10
    s_add_u32 s96, s96, s53
    s_waitcnt lgkmcnt(0)
    s_mov_b32 s16, s6
    s_mov_b32 s17, s7
    s_mov_b32 s18, 32505856
    s_mov_b32 s19, 0x20000
    s_mov_b64 s[98:99], s[14:15]
    s_mov_b32 s67, 0
    s_mov_b32 s68, 0
    s_lshr_b32 s92, s6, 7
    s_sub_u32 s92, 3, s92
    s_and_b32 s92, s92, 7
    s_lshl_b32 s53, s92, 7
    s_add_u32 s96, s96, s53
    s_xnor_b32 s93, s92, s46
    s_and_b32 s93, s93, 2
    s_cbranch_scc0 Lx
    s_mov_b32 s20, s14
    s_mov_b32 s21, s15
    s_mov_b32 s22, 67108864
    s_mov_b32 s23, 0x20000
    s_xor_b32 s86, s92, s46
    s_and_b32 s86, s86, 7
    s_xor_b32 s86, s86, 4
    s_lshr_b32 s52, s40, 1
    s_or_b32 s52, s52, s86
    s_cbranch_scc1 Lnopr
    s_xor_b32 s97, s40, s45
    s_and_b32 s97, s97, 1
    s_and_b32 s53, s2, 31
    s_lshl_b32 s53, s53, 1
    s_add_u32 s53, s53, s40
    s_mul_i32 s52, s53, 2130105
    s_and_b32 s52, s52, 0x1cf0000
    s_mul_i32 s67, s53, 43
    s_lshr_b32 s67, s67, 7
    s_mul_i32 s67, s67, 3
    s_sub_u32 s67, s53, s67
    s_lshl_b32 s68, s67, 20
    s_add_u32 s52, s52, s68
    s_lshr_b32 s67, s67, 1
    s_xor_b32 s67, s67, s97
    s_lshl_b32 s67, s67, 13
    s_xor_b32 s68, s67, 0x2000
    s_lshl_b32 s69, s53, 11
    s_and_b32 s69, s69, 0x1800
    s_add_u32 s52, s52, s69
    s_lshr_b32 s53, s53, 2
    s_lshl_b32 s53, s53, 7
    s_add_u32 s52, s52, s53
    s_add_u32 s52, s52, 33554432
    s_add_u32 s98, s14, s52
    s_addc_u32 s99, s15, 0
    v_lshrrev_b32 v124, 5, v1
    v_and_b32 v125, 31, v1
    v_lshlrev_b32 v124, 13, v124
    v_lshl_add_u32 v124, v125, 2, v124
    v_mov_b32 v125, 1
    buffer_store_dword v125, v124, s[20:23], s52 offen sc0 sc1
Lnopr:
    s_add_u32 m0, s47, 65536
    s_add_u32 s60, s48, 0
    buffer_load_dwordx4 v2, s[16:19], s60 offen  lds
    buffer_load_dwordx4 v2, s[16:19], s60 offen offset:2048  lds
    s_add_u32 m0, s47, 69632
    s_add_u32 s60, s48, 4096
    buffer_load_dwordx4 v3, s[16:19], s60 offen  lds
    buffer_load_dwordx4 v3, s[16:19], s60 offen offset:2048  lds
    s_add_u32 m0, s47, 73728
    s_add_u32 s60, s48, 8192
    buffer_load_dwordx4 v2, s[16:19], s60 offen  lds
    buffer_load_dwordx4 v2, s[16:19], s60 offen offset:2048  lds
    s_add_u32 m0, s47, 77824
    s_add_u32 s60, s48, 12288
    buffer_load_dwordx4 v3, s[16:19], s60 offen  lds
    buffer_load_dwordx4 v3, s[16:19], s60 offen offset:2048  lds
    s_mov_b32 s32, s8
    s_mov_b32 s33, s9
    s_mov_b32 s34, 524288
    s_mov_b32 s35, 0x20000
    v_mov_b32 v250, 0x7ffffff0
    v_mov_b32 v48, 0x7ffffff0
    s_mov_b32 s58, 0
    s_mov_b32 s101, 0
    s_branch Lbody
Lx:
    s_add_u32 s24, s4, s100
    s_addc_u32 s25, s5, 0
    s_mov_b32 s26, 1024000
    s_mov_b32 s27, 0x20000
    s_add_u32 m0, s59, 32768
    v_add_u32 v251, 0, v250
    buffer_load_dwordx4 v251, s[24:27], 0 offen lds
    s_add_u32 m0, s59, 33792
    v_add_u32 v252, 16384, v250
    buffer_load_dwordx4 v252, s[24:27], 0 offen lds
    s_add_u32 m0, s59, 34816
    v_add_u32 v253, 32768, v250
    buffer_load_dwordx4 v253, s[24:27], 0 offen lds
    s_add_u32 m0, s59, 35840
    v_add_u32 v254, 49152, v250
    buffer_load_dwordx4 v254, s[24:27], 0 offen lds
    s_add_u32 m0, s59, 36864
    v_add_u32 v255, 65536, v250
    buffer_load_dwordx4 v255, s[24:27], 0 offen lds
    s_mov_b32 s86, 1
    s_mov_b32 s32, s8
    s_mov_b32 s33, s9
    s_mov_b32 s34, 524288
    s_mov_b32 s35, 0x20000
    v_and_b32 v124, 0xfff00000, v2
    v_and_b32 v125, 1, v1
    v_lshl_add_u32 v124, v125, 11, v124
    s_lshl_b32 s52, s94, 11
    s_add_u32 s52, s52, s96
    s_add_u32 s52, s52, 65536
    buffer_load_dword v7, v124, s[16:19], s52 offen
    s_mov_b32 s20, s14
    s_mov_b32 s21, s15
    s_mov_b32 s22, 67108864
    s_mov_b32 s23, 0x20000
    v_bfe_u32 v152, v1, 3, 2
    v_bfe_u32 v153, v1, 2, 1
    v_bfe_u32 v154, v1, 1, 1
    v_and_b32 v155, 1, v1
    v_lshrrev_b32 v156, 5, v1
    v_lshl_add_u32 v157, v152, 1, v153
    v_mul_u32_u24 v154, 24, v154
    s_mul_i32 s52, s40, 6
    v_add3_u32 v157, v157, v154, s52
    v_lshl_add_u32 v157, v157, 2, 1
    v_cvt_f32_u32 v157, v157
    v_mul_f32 v157, 0x3baaaaab, v157
    v_cvt_f32_u32 v158, v155
    v_mul_f32 v158, 0x3e800000, v158
    v_lshlrev_b32 v159, 3, v156
    v_cvt_f32_u32 v159, v159
    v_fma_f32 v158, v157, v159, v158
    v_mul_u32_u24 v168, 0x8000, v155
    v_lshl_add_u32 v168, v168, 16, v168
    v_fmamk_f32 v160, v157, 0x00000000, v158
    v_fmamk_f32 v161, v157, 0x3f800000, v158
    v_fmamk_f32 v162, v157, 0x40000000, v158
    v_fmamk_f32 v163, v157, 0x40400000, v158
    v_fmamk_f32 v164, v157, 0x40800000, v158
    v_fmamk_f32 v165, v157, 0x40a00000, v158
    v_fmamk_f32 v166, v157, 0x40c00000, v158
    v_fmamk_f32 v167, v157, 0x40e00000, v158
    v_cos_f32 v160, v160
    v_cos_f32 v161, v161
    v_cos_f32 v162, v162
    v_cos_f32 v163, v163
    v_cos_f32 v164, v164
    v_cos_f32 v165, v165
    v_cos_f32 v166, v166
    v_cos_f32 v167, v167
    s_nop 0
    v_cvt_pk_bf16_f32 v128, v160, v161
    v_cvt_pk_bf16_f32 v129, v162, v163
    v_cvt_pk_bf16_f32 v130, v164, v165
    v_cvt_pk_bf16_f32 v131, v166, v167
    v_fmamk_f32 v160, v157, 0x41800000, v158
    v_fmamk_f32 v161, v157, 0x41880000, v158
    v_fmamk_f32 v162, v157, 0x41900000, v158
    v_fmamk_f32 v163, v157, 0x41980000, v158
    v_fmamk_f32 v164, v157, 0x41a00000, v158
    v_fmamk_f32 v165, v157, 0x41a80000, v158
    v_fmamk_f32 v166, v157, 0x41b00000, v158
    v_fmamk_f32 v167, v157, 0x41b80000, v158
    v_cos_f32 v160, v160
    v_cos_f32 v161, v161
    v_cos_f32 v162, v162
    v_cos_f32 v163, v163
    v_cos_f32 v164, v164
    v_cos_f32 v165, v165
    v_cos_f32 v166, v166
    v_cos_f32 v167, v167
    s_nop 0
    v_cvt_pk_bf16_f32 v132, v160, v161
    v_cvt_pk_bf16_f32 v133, v162, v163
    v_cvt_pk_bf16_f32 v134, v164, v165
    v_cvt_pk_bf16_f32 v135, v166, v167
    v_fmamk_f32 v160, v157, 0x42000000, v158
    v_fmamk_f32 v161, v157, 0x42040000, v158
    v_fmamk_f32 v162, v157, 0x42080000, v158
    v_fmamk_f32 v163, v157, 0x420c0000, v158
    v_fmamk_f32 v164, v157, 0x42100000, v158
    v_fmamk_f32 v165, v157, 0x42140000, v158
    v_fmamk_f32 v166, v157, 0x42180000, v158
    v_fmamk_f32 v167, v157, 0x421c0000, v158
    v_cos_f32 v160, v160
    v_cos_f32 v161, v161
    v_cos_f32 v162, v162
    v_cos_f32 v163, v163
    v_cos_f32 v164, v164
    v_cos_f32 v165, v165
    v_cos_f32 v166, v166
    v_cos_f32 v167, v167
    s_nop 0
    v_cvt_pk_bf16_f32 v136, v160, v161
    v_cvt_pk_bf16_f32 v137, v162, v163
    v_cvt_pk_bf16_f32 v138, v164, v165
    v_cvt_pk_bf16_f32 v139, v166, v167
    v_xor_b32_dpp v140, v128, v168 quad_perm:[1,0,3,2] row_mask:0xf bank_mask:0xf
    v_xor_b32_dpp v141, v129, v168 quad_perm:[1,0,3,2] row_mask:0xf bank_mask:0xf
    v_xor_b32_dpp v142, v130, v168 quad_perm:[1,0,3,2] row_mask:0xf bank_mask:0xf
    v_xor_b32_dpp v143, v131, v168 quad_perm:[1,0,3,2] row_mask:0xf bank_mask:0xf
    v_xor_b32_dpp v144, v132, v168 quad_perm:[1,0,3,2] row_mask:0xf bank_mask:0xf
    v_xor_b32_dpp v145, v133, v168 quad_perm:[1,0,3,2] row_mask:0xf bank_mask:0xf
    v_xor_b32_dpp v146, v134, v168 quad_perm:[1,0,3,2] row_mask:0xf bank_mask:0xf
    v_xor_b32_dpp v147, v135, v168 quad_perm:[1,0,3,2] row_mask:0xf bank_mask:0xf
    v_xor_b32_dpp v148, v136, v168 quad_perm:[1,0,3,2] row_mask:0xf bank_mask:0xf
    v_xor_b32_dpp v149, v137, v168 quad_perm:[1,0,3,2] row_mask:0xf bank_mask:0xf
    v_xor_b32_dpp v150, v138, v168 quad_perm:[1,0,3,2] row_mask:0xf bank_mask:0xf
    v_xor_b32_dpp v151, v139, v168 quad_perm:[1,0,3,2] row_mask:0xf bank_mask:0xf
    v_bfe_u32 v160, v1, 4, 1
    v_bfe_u32 v161, v1, 1, 1
    v_lshl_add_u32 v160, v160, 1, v161
    v_add_u32 v160, s40, v160
    v_and_b32 v160, 3, v160
    v_lshlrev_b32 v160, 4, v160
    v_lshl_add_u32 v160, v155, 3, v160
    v_bfe_u32 v161, v1, 2, 2
    v_lshl_add_u32 v161, v156, 3, v161
    v_lshl_add_u32 v160, v161, 7, v160
    v_add_u32 v248, 32768, v160
    s_bfe_u32 s52, s94, 0x30001
    v_and_b32 v160, 7, v1
    v_xor_b32 v160, s52, v160
    v_lshlrev_b32 v160, 4, v160
    v_lshl_add_u32 v160, v156, 12, v160
    v_lshl_add_u32 v160, v152, 16, v160
    v_cmp_eq_u32 vcc, 3, v152
    v_mov_b32 v161, 0x7ffffff0
    s_mul_i32 s58, s43, 786432
    s_mul_i32 s52, s40, 196608
    v_cndmask_b32 v250, v160, v161, vcc
    s_add_u32 s58, s58, s52
    s_lshr_b32 s52, s94, 4
    s_lshl_b32 s52, s52, 15
    s_add_u32 s58, s58, s52
    s_lshl_b32 s52, s44, 14
    s_add_u32 s58, s58, s52
    s_and_b32 s52, s94, 15
    s_lshl_b32 s52, s52, 7
    s_add_u32 s58, s58, s52
    v_cmp_gt_u32 vcc, 32, v1
    v_lshlrev_b32 v48, 2, v1
    v_mov_b32 v49, 0
    s_lshl_b32 s52, s94, 11
    s_lshl_b32 s53, s41, 9
    v_cndmask_b32 v48, v161, v48, vcc
    s_add_u32 s52, s52, s53
    s_lshl_b32 s53, s40, 16
    s_add_u32 s52, s52, s53
    s_add_u32 s100, s52, 31457280
    s_add_u32 s101, s58, 8192
    s_branch Lbody
.p2align 12
Lbody:
    s_mov_b32 s28, s12
    s_mov_b32 s29, s13
    s_mov_b32 s30, 256
    s_mov_b32 s31, 0x20000
    v_bfe_u32 v16, v1, 3, 2
    v_bfe_u32 v17, v1, 1, 1
    v_and_b32 v18, 1, v1
    v_bfe_u32 v19, v1, 2, 1
    v_lshrrev_b32 v20, 5, v1
    v_lshl_add_u32 v21, v16, 1, v17
    v_mul_u32_u24 v18, 24, v18
    s_mul_i32 s52, s45, 6
    v_add3_u32 v21, v21, v18, s52
    v_lshl_add_u32 v21, v21, 2, 1
    v_cvt_f32_u32_e64 v21, v21
    v_mul_f32 v21, 0x3baaaaab, v21
    v_cvt_f32_u32 v22, v19
    v_mul_f32 v22, 0x3e800000, v22
    v_lshlrev_b32 v23, 3, v20
    v_cvt_f32_u32_e64 v23, v23
    v_fma_f32 v22, v21, v23, v22
    v_fmamk_f32 v24, v21, 0x00000000, v22
    v_fmamk_f32 v25, v21, 0x3f800000, v22
    v_fmamk_f32 v26, v21, 0x40000000, v22
    v_fmamk_f32 v27, v21, 0x40400000, v22
    v_fmamk_f32 v28, v21, 0x40800000, v22
    v_fmamk_f32 v29, v21, 0x40a00000, v22
    v_fmamk_f32 v30, v21, 0x40c00000, v22
    v_fmamk_f32 v31, v21, 0x40e00000, v22
    v_cos_f32 v24, v24
    v_cos_f32 v25, v25
    v_cos_f32 v26, v26
    v_cos_f32 v27, v27
    v_cos_f32 v28, v28
    v_cos_f32 v29, v29
    v_cos_f32 v30, v30
    v_cos_f32_e64 v31, v31
    s_nop 0
    v_cvt_pk_bf16_f32 v8, v24, v25
    v_cvt_pk_bf16_f32 v9, v26, v27
    v_cvt_pk_bf16_f32 v10, v28, v29
    v_cvt_pk_bf16_f32 v11, v30, v31
    v_fmamk_f32 v24, v21, 0x41800000, v22
    v_fmamk_f32 v25, v21, 0x41880000, v22
    v_fmamk_f32 v26, v21, 0x41900000, v22
    v_fmamk_f32 v27, v21, 0x41980000, v22
    v_fmamk_f32 v28, v21, 0x41a00000, v22
    v_fmamk_f32 v29, v21, 0x41a80000, v22
    v_fmamk_f32 v30, v21, 0x41b00000, v22
    v_fmamk_f32 v31, v21, 0x41b80000, v22
    v_cos_f32 v24, v24
    v_cos_f32 v25, v25
    v_cos_f32 v26, v26
    v_cos_f32 v27, v27
    v_cos_f32 v28, v28
    v_cos_f32 v29, v29
    v_cos_f32 v30, v30
    v_cos_f32_e64 v31, v31
    s_nop 0
    v_cvt_pk_bf16_f32 v12, v24, v25
    v_cvt_pk_bf16_f32 v13, v26, v27
    v_cvt_pk_bf16_f32 v14, v28, v29
    v_cvt_pk_bf16_f32 v15, v30, v31
    v_bfe_u32 v16, v1, 4, 1
    v_bfe_u32 v17, v1, 2, 2
    v_and_b32 v18, 3, v1
    v_bfe_u32 v19, v1, 3, 2
    v_xor_b32 v19, s40, v19
    v_lshlrev_b32_e64 v4, 3, v18
    v_lshl_add_u32 v4, v19, 5, v4
    v_lshl_add_u32 v4, v17, 7, v4
    v_lshl_add_u32 v4, v20, 10, v4
    v_lshl_add_u32 v4, v16, 12, v4
    v_add_u32 v5, 0x10000, v4
    v_lshlrev_b32 v6, 4, v1
    s_mul_i32 s54, s43, 786432
    s_mul_i32 s52, s45, 196608
    s_add_u32 s54, s54, s52
    s_lshl_b32 s55, s40, 13
    s_add_u32 s54, s54, s55
    s_lshl_b32 s56, s46, 16
    s_mul_i32 s52, s43, 0x2800
    s_and_b32 s52, s52, 0x4800
    s_add_u32 s56, s56, s52
    s_lshl_b32 s52, s45, 9
    s_add_u32 s56, s56, s52
    s_lshl_b32 s52, s40, 7
    s_add_u32 s56, s56, s52
    s_lshl_b32 s57, s43, 6
    s_lshl_b32 s59, s42, 10
    s_add_u32 s59, s59, Lb-Lpc
    v_lshrrev_b32 v60, 6, v0
    v_and_b32 v61, 1, v0
    v_lshlrev_b32_e64 v60, 8, v60
    v_lshl_add_u32 v60, v61, 7, v60
    v_add_u32_e64 v60, s59, v60
    v_min_u32 v60, Lend-Lpc, v60
    v_mov_b32 v63, s63
    v_add_co_u32 v62, vcc, s62, v60
    s_nop 1
    v_addc_co_u32 v63, vcc, 0, v63, vcc
    v_bfe_u32 v16, v1, 3, 2
    v_cmp_eq_u32 vcc, 3, v16
    s_nop 1
    v_cndmask_b32 v8, v8, 0, vcc
    v_cndmask_b32 v9, v9, 0, vcc
    v_cndmask_b32 v10, v10, 0, vcc
    v_cndmask_b32 v11, v11, 0, vcc
    v_cndmask_b32 v12, v12, 0, vcc
    v_cndmask_b32 v13, v13, 0, vcc
    v_cndmask_b32 v14, v14, 0, vcc
    v_cndmask_b32 v15, v15, 0, vcc
    v_add_u32 v56, 0x20000, v4
    v_and_b32_e64 v57, 3, v1
    v_lshlrev_b32 v57, 6, v57
    v_cmp_lt_u32 vcc, 31, v1
    s_nop 1
    v_cndmask_b32 v57, v57, 32, vcc
    v_mov_b32 v16, 0x7ffffff0
    v_and_b32 v17, 15, v1
    v_lshrrev_b32_e64 v18, 4, v1
    v_cmp_gt_u32 vcc, 64, v0
    v_bfe_u32 v19, v1, 1, 3
    v_lshlrev_b32_e64 v59, 4, v19
    v_cndmask_b32 v57, v16, v57, vcc
    v_lshl_add_u32 v59, v17, 7, v59
    v_lshl_add_u32 v59, v18, 11, v59
    v_add_u32 v59, 98304, v59
    s_lshl_b32 s65, s40, 10
    s_mov_b32 s64, s45
    s_lshl_b32 s64, s64, 8
    s_lshl_b32 s53, s40, 12
    s_add_u32 s64, s64, s53
    s_lshr_b32 s61, s2, 6
    s_lshl_b32 s61, s61, 11
    s_add_u32 s61, s61, 31457280
    s_and_b32 s3, s2, 3
    s_lshl_b32 s53, s45, 2
    s_add_u32 s3, s3, s53
    s_and_b32 s53, s2, 4
    s_lshl_b32 s53, s53, 2
    s_add_u32 s3, s3, s53
    s_lshl_b32 s3, s3, 9
    s_xor_b32 s3, s3, 31465472
    v_mov_b32 v58, v16
    s_or_b32 s95, s93, s40
    s_xor_b32 s52, s46, s92
    s_bfe_u32 s53, s52, 65538
    s_lshl_b32 s53, s53, 2
    s_add_u32 s53, s53, s45
    s_lshl_b32 s53, s53, 2
    s_add_u32 s53, s53, s40
    s_lshl_b32 s53, s53, 11
    s_add_u32 s96, s96, s53
    s_add_u32 s96, s96, 196608
    s_and_b32 s52, s52, 3
    s_cmp_eq_u32 s52, 1
    s_cselect_b32 s52, 0, 31
    v_and_b32_e64 v60, 31, v1
    v_or_b32 v60, s52, v60
    v_lshlrev_b32_e64 v60, 20, v60
    s_xor_b32 s52, s40, 0
    s_or_b32 s52, s52, s86
    s_cbranch_scc1 Lnovote0
    s_mov_b32 s53, 0
    s_waitcnt vmcnt(8)
    s_load_dword s52, s[98:99], s67
    s_load_dword s53, s[98:99], s68
    s_waitcnt lgkmcnt(1)
    s_xor_b32 s97, s97, s44
    s_lshl_b32 s97, s97, 3
    s_lshl_b32 s97, 1, s97
    s_mov_b32 s59, 32768
    v_mov_b32_e64 v61, s59
    v_mov_b32_e64 v251, 0
    v_mov_b32_e64 v252, s97
    s_cmp_eq_u32 s53, 0
    s_cselect_b64 vcc, -1, 0
    s_waitcnt lgkmcnt(0)
    v_cndmask_b32 v251, v251, v252, vcc
    ds_write_b32 v61, v251
    s_waitcnt lgkmcnt(0)
Lnovote0:
    s_cmp_lg_u32 s93, 0
    s_cbranch_scc1 Lwarm
    s_add_u32 m0, s47, 65536
    s_add_u32 s60, s48, 0
    buffer_load_dwordx4 v2, s[16:19], s60 offen  lds
    buffer_load_dwordx4 v2, s[16:19], s60 offen offset:2048  lds
    s_add_u32 m0, s47, 69632
    s_add_u32 s60, s48, 4096
    buffer_load_dwordx4 v3, s[16:19], s60 offen  lds
    buffer_load_dwordx4 v3, s[16:19], s60 offen offset:2048  lds
    s_add_u32 m0, s47, 73728
    s_add_u32 s60, s48, 8192
    buffer_load_dwordx4 v2, s[16:19], s60 offen  lds
    buffer_load_dwordx4 v2, s[16:19], s60 offen offset:2048  lds
    s_add_u32 m0, s47, 77824
    s_add_u32 s60, s48, 12288
    buffer_load_dwordx4 v3, s[16:19], s60 offen  lds
    buffer_load_dwordx4 v3, s[16:19], s60 offen offset:2048  lds
    s_waitcnt vmcnt(9)
    s_barrier
    ds_read_b64_tr_b16 v[152:153], v248 offset:0
    ds_read_b64_tr_b16 v[154:155], v248 offset:512
    ds_read_b64_tr_b16 v[156:157], v248 offset:2048
    ds_read_b64_tr_b16 v[158:159], v248 offset:2560
    ds_read_b64_tr_b16 v[160:161], v248 offset:4096
    ds_read_b64_tr_b16 v[162:163], v248 offset:4608
    ds_read_b64_tr_b16 v[164:165], v248 offset:6144
    ds_read_b64_tr_b16 v[166:167], v248 offset:6656
    ds_read_b64_tr_b16 v[168:169], v248 offset:8192
    ds_read_b64_tr_b16 v[170:171], v248 offset:8704
    ds_read_b64_tr_b16 v[172:173], v248 offset:10240
    ds_read_b64_tr_b16 v[174:175], v248 offset:10752
    s_waitcnt lgkmcnt(10)
    v_mfma_f32_32x32x16_bf16 v[64:79], v[152:155], v[128:131], 0
    ds_read_b64_tr_b16 v[176:177], v248 offset:12288
    ds_read_b64_tr_b16 v[178:179], v248 offset:12800
    s_waitcnt lgkmcnt(10)
    v_mfma_f32_32x32x16_bf16 v[64:79], v[156:159], v[132:135], v[64:79]
    ds_read_b64_tr_b16 v[180:181], v248 offset:14336
    ds_read_b64_tr_b16 v[182:183], v248 offset:14848
    s_waitcnt lgkmcnt(10)
    v_mfma_f32_32x32x16_bf16 v[64:79], v[160:163], v[136:139], v[64:79]
    ds_read_b64_tr_b16 v[184:185], v248 offset:16384
    ds_read_b64_tr_b16 v[186:187], v248 offset:16896
    s_waitcnt lgkmcnt(10)
    v_mfma_f32_32x32x16_bf16 v[64:79], v[164:167], v[140:143], v[64:79]
    ds_read_b64_tr_b16 v[188:189], v248 offset:18432
    ds_read_b64_tr_b16 v[190:191], v248 offset:18944
    s_waitcnt lgkmcnt(10)
    v_mfma_f32_32x32x16_bf16 v[64:79], v[168:171], v[144:147], v[64:79]
    ds_read_b64_tr_b16 v[192:193], v248 offset:64
    ds_read_b64_tr_b16 v[194:195], v248 offset:576
    s_waitcnt lgkmcnt(10)
    v_mfma_f32_32x32x16_bf16 v[64:79], v[172:175], v[148:151], v[64:79]
    ds_read_b64_tr_b16 v[196:197], v248 offset:2112
    ds_read_b64_tr_b16 v[198:199], v248 offset:2624
    s_waitcnt lgkmcnt(14)
    v_mfma_f32_32x32x16_bf16 v[80:95], v[168:171], v[128:131], 0
    ds_read_b64_tr_b16 v[200:201], v248 offset:4160
    ds_read_b64_tr_b16 v[202:203], v248 offset:4672
    s_waitcnt lgkmcnt(14)
    v_mfma_f32_32x32x16_bf16 v[80:95], v[172:175], v[132:135], v[80:95]
    ds_read_b64_tr_b16 v[204:205], v248 offset:6208
    ds_read_b64_tr_b16 v[206:207], v248 offset:6720
    s_waitcnt lgkmcnt(14)
    v_mfma_f32_32x32x16_bf16 v[80:95], v[176:179], v[136:139], v[80:95]
    ds_read_b64_tr_b16 v[208:209], v248 offset:8256
    ds_read_b64_tr_b16 v[210:211], v248 offset:8768
    s_waitcnt lgkmcnt(14)
    v_mfma_f32_32x32x16_bf16 v[80:95], v[180:183], v[140:143], v[80:95]
    ds_read_b64_tr_b16 v[212:213], v248 offset:10304
    ds_read_b64_tr_b16 v[214:215], v248 offset:10816
    s_waitcnt lgkmcnt(14)
    v_mfma_f32_32x32x16_bf16 v[80:95], v[184:187], v[144:147], v[80:95]
    ds_read_b64_tr_b16 v[216:217], v248 offset:12352
    ds_read_b64_tr_b16 v[218:219], v248 offset:12864
    s_waitcnt lgkmcnt(14)
    v_mfma_f32_32x32x16_bf16 v[80:95], v[188:191], v[148:151], v[80:95]
    ds_read_b64_tr_b16 v[220:221], v248 offset:14400
    ds_read_b64_tr_b16 v[222:223], v248 offset:14912
    s_waitcnt lgkmcnt(14)
    v_mfma_f32_32x32x16_bf16 v[96:111], v[192:195], v[128:131], 0
    ds_read_b64_tr_b16 v[224:225], v248 offset:16448
    ds_read_b64_tr_b16 v[226:227], v248 offset:16960
    s_waitcnt lgkmcnt(14)
    v_mfma_f32_32x32x16_bf16 v[96:111], v[196:199], v[132:135], v[96:111]
    ds_read_b64_tr_b16 v[228:229], v248 offset:18496
    ds_read_b64_tr_b16 v[230:231], v248 offset:19008
    s_waitcnt lgkmcnt(14)
    v_mfma_f32_32x32x16_bf16 v[96:111], v[200:203], v[136:139], v[96:111]
    s_waitcnt lgkmcnt(12)
    v_mfma_f32_32x32x16_bf16 v[96:111], v[204:207], v[140:143], v[96:111]
    s_waitcnt lgkmcnt(10)
    v_mfma_f32_32x32x16_bf16 v[96:111], v[208:211], v[144:147], v[96:111]
    s_waitcnt lgkmcnt(8)
    v_mfma_f32_32x32x16_bf16 v[96:111], v[212:215], v[148:151], v[96:111]
    s_waitcnt lgkmcnt(10)
    v_mfma_f32_32x32x16_bf16 v[112:127], v[208:211], v[128:131], 0
    s_waitcnt lgkmcnt(8)
    v_mfma_f32_32x32x16_bf16 v[112:127], v[212:215], v[132:135], v[112:127]
    s_waitcnt lgkmcnt(6)
    v_mfma_f32_32x32x16_bf16 v[112:127], v[216:219], v[136:139], v[112:127]
    s_waitcnt lgkmcnt(4)
    v_mfma_f32_32x32x16_bf16 v[112:127], v[220:223], v[140:143], v[112:127]
    s_waitcnt lgkmcnt(2)
    v_mfma_f32_32x32x16_bf16 v[112:127], v[224:227], v[144:147], v[112:127]
    s_waitcnt lgkmcnt(0)
    v_mfma_f32_32x32x16_bf16 v[112:127], v[228:231], v[148:151], v[112:127]
    v_cvt_pk_bf16_f32 v140, v64, v65
    v_cvt_pk_bf16_f32 v141, v68, v69
    v_cvt_pk_bf16_f32 v142, v72, v73
    v_cvt_pk_bf16_f32 v143, v76, v77
    v_cvt_pk_bf16_f32 v156, v66, v67
    v_cvt_pk_bf16_f32 v157, v70, v71
    v_cvt_pk_bf16_f32 v158, v74, v75
    v_cvt_pk_bf16_f32 v159, v78, v79
    v_cvt_pk_bf16_f32 v172, v80, v81
    v_cvt_pk_bf16_f32 v173, v84, v85
    v_cvt_pk_bf16_f32 v174, v88, v89
    v_cvt_pk_bf16_f32 v175, v92, v93
    v_cvt_pk_bf16_f32 v188, v82, v83
    v_cvt_pk_bf16_f32 v189, v86, v87
    v_cvt_pk_bf16_f32 v190, v90, v91
    v_cvt_pk_bf16_f32 v191, v94, v95
    v_cvt_pk_bf16_f32 v204, v96, v97
    v_cvt_pk_bf16_f32 v205, v100, v101
    v_cvt_pk_bf16_f32 v206, v104, v105
    v_cvt_pk_bf16_f32 v207, v108, v109
    v_cvt_pk_bf16_f32 v220, v98, v99
    v_cvt_pk_bf16_f32 v221, v102, v103
    v_cvt_pk_bf16_f32 v222, v106, v107
    v_cvt_pk_bf16_f32 v223, v110, v111
    v_cvt_pk_bf16_f32 v236, v112, v113
    v_cvt_pk_bf16_f32 v237, v116, v117
    v_cvt_pk_bf16_f32 v238, v120, v121
    v_cvt_pk_bf16_f32 v239, v124, v125
    v_cvt_pk_bf16_f32 v252, v114, v115
    v_cvt_pk_bf16_f32 v253, v118, v119
    v_cvt_pk_bf16_f32 v254, v122, v123
    v_cvt_pk_bf16_f32 v255, v126, v127
Lwarm:
    s_mov_b64 exec, 0
    s_cmp_eq_u32 s40, 0
    s_cbranch_scc1 Lpg1
    s_cmp_eq_u32 s40, 1
    s_cbranch_scc1 Lpg2
    s_cmp_eq_u32 s40, 2
    s_cbranch_scc1 Lpg3
    s_branch Lpg4
Lpg8:
Lback:
    s_mov_b64 exec, -1
    s_cmp_lg_u32 s93, 0
    s_cbranch_scc1 Lnost
    buffer_store_dwordx4 v[140:143], v250, s[20:23], s58 offen offset:0 sc0 sc1
    buffer_store_dwordx4 v[156:159], v250, s[20:23], s58 offen offset:2048 sc0 sc1
    buffer_store_dwordx4 v[172:175], v250, s[20:23], s58 offen offset:128 sc0 sc1
    buffer_store_dwordx4 v[188:191], v250, s[20:23], s58 offen offset:2176 sc0 sc1
    buffer_store_dwordx4 v[204:207], v250, s[20:23], s101 offen offset:0 sc0 sc1
    buffer_store_dwordx4 v[220:223], v250, s[20:23], s101 offen offset:2048 sc0 sc1
    buffer_store_dwordx4 v[236:239], v250, s[20:23], s101 offen offset:128 sc0 sc1
    buffer_store_dwordx4 v[252:255], v250, s[20:23], s101 offen offset:2176 sc0 sc1
    buffer_store_dword v49, v48, s[20:23], s100 offen sc0 sc1
Lnost:
    s_xor_b32 s52, s40, 1
    s_or_b32 s52, s52, s86
    s_cbranch_scc1 Lnovote1
    s_mov_b32 s53, 0
    s_waitcnt vmcnt(8)
    s_load_dword s52, s[98:99], s67
    s_load_dword s53, s[98:99], s68
    s_waitcnt lgkmcnt(1)
    s_xor_b32 s97, s97, s44
    s_lshl_b32 s97, s97, 3
    s_lshl_b32 s97, 1, s97
    s_mov_b32 s59, 32772
    v_mov_b32_e64 v61, s59
    v_mov_b32 v251, 0
    v_mov_b32 v252, s97
    s_cmp_eq_u32 s53, 0
    s_cselect_b64 vcc, -1, 0
    s_waitcnt lgkmcnt(0)
    v_cndmask_b32 v251, v251, v252, vcc
    ds_write_b32 v61, v251
    s_waitcnt lgkmcnt(0)
Lnovote1:
    s_add_u32 m0, s47, 98304
    s_add_u32 s60, s49, 0
    buffer_load_dwordx4 v2, s[16:19], s60 offen  lds
    buffer_load_dwordx4 v2, s[16:19], s60 offen offset:2048  lds
    s_add_u32 m0, s47, 102400
    s_add_u32 s60, s49, 4096
    buffer_load_dwordx4 v3, s[16:19], s60 offen  lds
    buffer_load_dwordx4 v3, s[16:19], s60 offen offset:2048  lds
    s_add_u32 m0, s47, 106496
    s_add_u32 s60, s49, 8192
    buffer_load_dwordx4 v2, s[16:19], s60 offen  lds
    buffer_load_dwordx4 v2, s[16:19], s60 offen offset:2048  lds
    s_add_u32 m0, s47, 110592
    s_add_u32 s60, s49, 12288
    buffer_load_dwordx4 v3, s[16:19], s60 offen  lds
    buffer_load_dwordx4 v3, s[16:19], s60 offen offset:2048  lds
    s_cmp_eq_u32 s86, 0
    s_cselect_b32 s97, 0xffff, 0
    s_cselect_b32 s57, 32, s57
    s_cselect_b32 s95, s40, s95
    s_add_u32 m0, s47, 131072
    s_add_u32 s60, s50, 0
    s_cmp_lg_u32 s93, 0
    s_cbranch_scc1 Lw0e
    s_waitcnt vmcnt(17)
    s_branch Lw0
Lw0e:
    s_waitcnt vmcnt(8)
Lw0:
    s_barrier
    s_cmp_lg_u32 s86, 0
    s_cbranch_scc1 Lnotally
    v_mov_b32 v61, 32768
    ds_read_b64 v[250:251], v61
Lnotally:
    ds_read_b64_tr_b16 v[32:33], v5 offset:0
    ds_read_b64_tr_b16 v[34:35], v5 offset:512
    buffer_load_dwordx4 v2, s[16:19], s60 offen  lds
    ds_read_b64_tr_b16 v[36:37], v5 offset:16384
    ds_read_b64_tr_b16 v[38:39], v5 offset:16896
    buffer_load_dwordx4 v2, s[16:19], s60 offen offset:2048  lds
    s_add_u32 m0, s47, 135168
    s_add_u32 s60, s50, 4096
    buffer_load_dwordx4 v3, s[16:19], s60 offen  lds
    buffer_load_dwordx4 v3, s[16:19], s60 offen offset:2048  lds
    s_add_u32 m0, s47, 139264
    s_add_u32 s60, s50, 8192
    ds_read_b64_tr_b16 v[40:41], v5 offset:2048
    ds_read_b64_tr_b16 v[42:43], v5 offset:2560
    buffer_load_dwordx4 v2, s[16:19], s60 offen  lds
    ds_read_b64_tr_b16 v[44:45], v5 offset:18432
    ds_read_b64_tr_b16 v[46:47], v5 offset:18944
    buffer_load_dwordx4 v2, s[16:19], s60 offen offset:2048  lds
    s_add_u32 m0, s47, 143360
    s_add_u32 s60, s50, 12288
    buffer_load_dwordx4 v3, s[16:19], s60 offen  lds
    buffer_load_dwordx4 v3, s[16:19], s60 offen offset:2048  lds
    s_add_u32 m0, s47, 0
    s_add_u32 s60, s51, 0
    s_waitcnt lgkmcnt(4)
    v_mfma_f32_32x32x16_bf16 v[64:79], v[8:11], v[32:35], 0
    ds_read_b64_tr_b16 v[48:49], v5 offset:8192
    ds_read_b64_tr_b16 v[50:51], v5 offset:8704
    buffer_load_dwordx4 v2, s[16:19], s60 offen  lds
    v_mfma_f32_32x32x16_bf16 v[64:79], v[12:15], v[36:39], v[64:79]
    ds_read_b64_tr_b16 v[52:53], v5 offset:24576
    ds_read_b64_tr_b16 v[54:55], v5 offset:25088
    buffer_load_dwordx4 v2, s[16:19], s60 offen offset:2048  lds
    s_add_u32 m0, s47, 4096
    s_add_u32 s60, s51, 4096
    buffer_load_dwordx4 v3, s[16:19], s60 offen  lds
    buffer_load_dwordx4 v3, s[16:19], s60 offen offset:2048  lds
    s_add_u32 m0, s47, 8192
    s_add_u32 s60, s51, 8192
    s_waitcnt lgkmcnt(4)
    v_mfma_f32_32x32x16_bf16 v[80:95], v[8:11], v[40:43], 0
    ds_read_b64_tr_b16 v[32:33], v5 offset:10240
    ds_read_b64_tr_b16 v[34:35], v5 offset:10752
    buffer_load_dwordx4 v2, s[16:19], s60 offen  lds
    v_mfma_f32_32x32x16_bf16 v[80:95], v[12:15], v[44:47], v[80:95]
    ds_read_b64_tr_b16 v[36:37], v5 offset:26624
    ds_read_b64_tr_b16 v[38:39], v5 offset:27136
    buffer_load_dwordx4 v2, s[16:19], s60 offen offset:2048  lds
    s_add_u32 m0, s47, 12288
    s_add_u32 s60, s51, 12288
    buffer_load_dwordx4 v3, s[16:19], s60 offen  lds
    buffer_load_dwordx4 v3, s[16:19], s60 offen offset:2048  lds
    s_add_u32 m0, s47, 32768
    s_add_u32 s60, s48, 65536
    s_waitcnt vmcnt(16) lgkmcnt(4)
    s_barrier
    v_mfma_f32_32x32x16_bf16 v[96:111], v[8:11], v[48:51], 0
    ds_read_b64_tr_b16 v[40:41], v5 offset:32768
    ds_read_b64_tr_b16 v[42:43], v5 offset:33280
    s_cmp_lg_u32 s95, 0
    s_cbranch_scc1 Lnosig
    v_add_u32_e64 v7, v250, v251
    v_and_b32 v7, s97, v7
    v_add_u32 v7, 0x10000, v7
    s_mov_b64 exec, 1
    buffer_atomic_add v7, off, s[28:31], s57 sc1
    s_mov_b64 exec, -1
    s_branch Lsig
Lnosig:
    buffer_load_dword v7, v58, s[28:31], 0 offen
Lsig:
    buffer_load_dwordx4 v2, s[16:19], s60 offen  lds
    v_mfma_f32_32x32x16_bf16 v[96:111], v[12:15], v[52:55], v[96:111]
    ds_read_b64_tr_b16 v[44:45], v5 offset:49152
    ds_read_b64_tr_b16 v[46:47], v5 offset:49664
    buffer_load_dwordx4 v2, s[16:19], s60 offen offset:2048  lds
    s_add_u32 m0, s47, 36864
    s_add_u32 s60, s48, 69632
    s_waitcnt lgkmcnt(4)
    v_mfma_f32_32x32x16_bf16 v[112:127], v[8:11], v[32:35], 0
    ds_read_b64_tr_b16 v[48:49], v5 offset:34816
    ds_read_b64_tr_b16 v[50:51], v5 offset:35328
    buffer_load_dwordx4 v3, s[16:19], s60 offen  lds
    v_cvt_pk_bf16_f32 v16, v68, v84
    v_cvt_pk_bf16_f32 v17, v69, v85
    v_cvt_pk_bf16_f32 v18, v70, v86
    v_cvt_pk_bf16_f32 v19, v71, v87
    v_cvt_pk_bf16_f32 v20, v72, v88
    v_cvt_pk_bf16_f32 v21, v73, v89
    v_mfma_f32_32x32x16_bf16 v[112:127], v[12:15], v[36:39], v[112:127]
    ds_read_b64_tr_b16 v[52:53], v5 offset:51200
    ds_read_b64_tr_b16 v[54:55], v5 offset:51712
    buffer_load_dwordx4 v3, s[16:19], s60 offen offset:2048  lds
    v_cvt_pk_bf16_f32 v22, v74, v90
    v_cvt_pk_bf16_f32 v23, v75, v91
    v_cvt_pk_bf16_f32 v128, v64, v80
    v_cvt_pk_bf16_f32 v129, v65, v81
    v_cvt_pk_bf16_f32 v130, v66, v82
    v_cvt_pk_bf16_f32 v131, v67, v83
    s_add_u32 m0, s47, 40960
    s_add_u32 s60, s48, 73728
    s_waitcnt lgkmcnt(4)
    v_mfma_f32_32x32x16_bf16 v[64:79], v[8:11], v[40:43], 0
    ds_read_b64_tr_b16 v[32:33], v5 offset:40960
    ds_read_b64_tr_b16 v[34:35], v5 offset:41472
    buffer_load_dwordx4 v2, s[16:19], s60 offen  lds
    v_cvt_pk_bf16_f32 v24, v100, v116
    v_cvt_pk_bf16_f32 v25, v101, v117
    v_cvt_pk_bf16_f32 v26, v102, v118
    v_cvt_pk_bf16_f32 v27, v103, v119
    v_cvt_pk_bf16_f32 v28, v104, v120
    v_cvt_pk_bf16_f32 v29, v105, v121
    v_cvt_pk_bf16_f32 v30, v106, v122
    v_cvt_pk_bf16_f32 v31, v107, v123
    v_cvt_pk_bf16_f32 v132, v96, v112
    v_mfma_f32_32x32x16_bf16 v[64:79], v[12:15], v[44:47], v[64:79]
    ds_read_b64_tr_b16 v[36:37], v5 offset:57344
    ds_read_b64_tr_b16 v[38:39], v5 offset:57856
    buffer_load_dwordx4 v2, s[16:19], s60 offen offset:2048  lds
    v_cvt_pk_bf16_f32 v133, v97, v113
    v_cvt_pk_bf16_f32 v134, v98, v114
    v_cvt_pk_bf16_f32 v135, v99, v115
    v_permlane32_swap_b32 v16, v24
    v_permlane32_swap_b32 v17, v25
    v_permlane32_swap_b32 v18, v26
    s_add_u32 m0, s47, 45056
    s_add_u32 s60, s48, 77824
    s_waitcnt lgkmcnt(4)
    v_mfma_f32_32x32x16_bf16 v[80:95], v[8:11], v[48:51], 0
    ds_read_b64_tr_b16 v[40:41], v5 offset:43008
    ds_read_b64_tr_b16 v[42:43], v5 offset:43520
    buffer_load_dwordx4 v3, s[16:19], s60 offen  lds
    v_permlane32_swap_b32 v19, v27
    v_permlane32_swap_b32 v20, v28
    v_permlane32_swap_b32 v21, v29
    v_permlane32_swap_b32 v22, v30
    v_permlane32_swap_b32_e64 v23, v31
    v_mfma_f32_32x32x16_bf16 v[80:95], v[12:15], v[52:55], v[80:95]
    ds_read_b64_tr_b16 v[44:45], v5 offset:59392
    ds_read_b64_tr_b16 v[46:47], v5 offset:59904
    buffer_load_dwordx4 v3, s[16:19], s60 offen offset:2048  lds
    v_permlane32_swap_b32 v128, v132
    v_permlane32_swap_b32 v129, v133
    v_permlane32_swap_b32 v130, v134
    v_permlane32_swap_b32 v131, v135
    s_waitcnt vmcnt(17) lgkmcnt(4)
    s_barrier
    v_mfma_f32_32x32x16_bf16 v[96:111], v[8:11], v[32:35], 0
    ds_read_b64_tr_b16 v[48:49], v56 offset:0
    ds_read_b64_tr_b16 v[50:51], v56 offset:512
    v_accvgpr_write_b32 a32, v16
    v_accvgpr_write_b32 a40, v17
    v_accvgpr_write_b32 a48, v18
    v_accvgpr_write_b32 a56, v19
    v_accvgpr_write_b32 a64, v20
    v_accvgpr_write_b32 a72, v21
    v_accvgpr_write_b32 a80, v22
    v_accvgpr_write_b32 a88, v23
    v_accvgpr_write_b32 a0, v128
    v_mfma_f32_32x32x16_bf16 v[96:111], v[12:15], v[36:39], v[96:111]
    ds_read_b64_tr_b16 v[52:53], v56 offset:16384
    ds_read_b64_tr_b16 v[54:55], v56 offset:16896
    v_accvgpr_write_b32 a8, v129
    v_accvgpr_write_b32 a16, v130
    v_accvgpr_write_b32 a24, v131
    v_accvgpr_write_b32 a36, v24
    v_accvgpr_write_b32 a44, v25
    v_accvgpr_write_b32 a52, v26
    v_accvgpr_write_b32 a60, v27
    v_accvgpr_write_b32 a68, v28
    v_accvgpr_write_b32 a76, v29
    s_waitcnt lgkmcnt(4)
    v_mfma_f32_32x32x16_bf16 v[112:127], v[8:11], v[40:43], 0
    ds_read_b64_tr_b16 v[32:33], v56 offset:2048
    ds_read_b64_tr_b16 v[34:35], v56 offset:2560
    v_accvgpr_write_b32 a84, v30
    v_accvgpr_write_b32 a92, v31
    v_accvgpr_write_b32 a4, v132
    v_accvgpr_write_b32 a12, v133
    v_accvgpr_write_b32 a20, v134
    v_accvgpr_write_b32 a28, v135
    v_cvt_pk_bf16_f32 v16, v68, v84
    v_cvt_pk_bf16_f32 v17, v69, v85
    v_cvt_pk_bf16_f32 v18, v70, v86
    v_mfma_f32_32x32x16_bf16 v[112:127], v[12:15], v[44:47], v[112:127]
    ds_read_b64_tr_b16 v[36:37], v56 offset:18432
    ds_read_b64_tr_b16 v[38:39], v56 offset:18944
    v_cvt_pk_bf16_f32 v19, v71, v87
    v_cvt_pk_bf16_f32 v20, v72, v88
    v_cvt_pk_bf16_f32 v21, v73, v89
    v_cvt_pk_bf16_f32 v22, v74, v90
    v_cvt_pk_bf16_f32 v23, v75, v91
    v_cvt_pk_bf16_f32 v128, v64, v80
    v_cvt_pk_bf16_f32 v129, v65, v81
    v_cvt_pk_bf16_f32 v130, v66, v82
    v_cvt_pk_bf16_f32 v131, v67, v83
    s_waitcnt lgkmcnt(4)
    v_mfma_f32_32x32x16_bf16 v[64:79], v[8:11], v[48:51], 0
    ds_read_b64_tr_b16 v[40:41], v56 offset:8192
    ds_read_b64_tr_b16 v[42:43], v56 offset:8704
    v_cvt_pk_bf16_f32 v24, v100, v116
    v_cvt_pk_bf16_f32 v25, v101, v117
    v_cvt_pk_bf16_f32 v26, v102, v118
    v_cvt_pk_bf16_f32 v27, v103, v119
    v_cvt_pk_bf16_f32 v28, v104, v120
    v_cvt_pk_bf16_f32 v29, v105, v121
    v_cvt_pk_bf16_f32 v30, v106, v122
    v_cvt_pk_bf16_f32 v31, v107, v123
    v_cvt_pk_bf16_f32 v132, v96, v112
    v_mfma_f32_32x32x16_bf16 v[64:79], v[12:15], v[52:55], v[64:79]
    ds_read_b64_tr_b16 v[44:45], v56 offset:24576
    ds_read_b64_tr_b16 v[46:47], v56 offset:25088
    v_cvt_pk_bf16_f32 v133, v97, v113
    v_cvt_pk_bf16_f32 v134, v98, v114
    v_cvt_pk_bf16_f32 v135, v99, v115
Lpg1:
    s_cbranch_execz Lpg5
    v_permlane32_swap_b32 v16, v24
    v_permlane32_swap_b32 v17, v25
    v_permlane32_swap_b32_e64 v18, v26
    s_waitcnt lgkmcnt(4)
    v_mfma_f32_32x32x16_bf16 v[80:95], v[8:11], v[32:35], 0
    ds_read_b64_tr_b16 v[48:49], v56 offset:10240
    ds_read_b64_tr_b16 v[50:51], v56 offset:10752
    v_permlane32_swap_b32 v19, v27
    v_permlane32_swap_b32 v20, v28
    v_permlane32_swap_b32 v21, v29
    v_permlane32_swap_b32 v22, v30
    v_permlane32_swap_b32 v23, v31
    v_mfma_f32_32x32x16_bf16 v[80:95], v[12:15], v[36:39], v[80:95]
    ds_read_b64_tr_b16 v[52:53], v56 offset:26624
    ds_read_b64_tr_b16 v[54:55], v56 offset:27136
    v_permlane32_swap_b32 v128, v132
    v_permlane32_swap_b32 v129, v133
    v_permlane32_swap_b32 v130, v134
    v_permlane32_swap_b32_e64 v131, v135
    s_add_u32 m0, s47, 65536
    s_add_u32 s60, s49, 65536
    s_waitcnt vmcnt(9) lgkmcnt(4)
    s_barrier
    v_mfma_f32_32x32x16_bf16 v[96:111], v[8:11], v[40:43], 0
    ds_read_b64_tr_b16 v[32:33], v4 offset:0
    ds_read_b64_tr_b16 v[34:35], v4 offset:512
    buffer_load_dwordx4 v2, s[16:19], s60 offen  lds
    v_accvgpr_write_b32 a33, v16
    v_accvgpr_write_b32 a41, v17
    v_accvgpr_write_b32 a49, v18
    v_accvgpr_write_b32 a57, v19
    v_accvgpr_write_b32 a65, v20
    v_accvgpr_write_b32 a73, v21
    v_accvgpr_write_b32 a81, v22
    v_accvgpr_write_b32 a89, v23
    v_accvgpr_write_b32 a1, v128
    v_mfma_f32_32x32x16_bf16 v[96:111], v[12:15], v[44:47], v[96:111]
    ds_read_b64_tr_b16 v[36:37], v4 offset:16384
    ds_read_b64_tr_b16 v[38:39], v4 offset:16896
    buffer_load_dwordx4 v2, s[16:19], s60 offen offset:2048  lds
    v_accvgpr_write_b32 a9, v129
    v_accvgpr_write_b32 a17, v130
    v_accvgpr_write_b32 a25, v131
    v_accvgpr_write_b32 a37, v24
    v_accvgpr_write_b32 a45, v25
    v_accvgpr_write_b32 a53, v26
    v_accvgpr_write_b32 a61, v27
    v_accvgpr_write_b32 a69, v28
    v_accvgpr_write_b32 a77, v29
    s_add_u32 m0, s47, 69632
    s_add_u32 s60, s49, 69632
    s_waitcnt lgkmcnt(4)
    v_mfma_f32_32x32x16_bf16 v[112:127], v[8:11], v[48:51], 0
    ds_read_b64_tr_b16 v[40:41], v4 offset:2048
    ds_read_b64_tr_b16 v[42:43], v4 offset:2560
    buffer_load_dwordx4 v3, s[16:19], s60 offen  lds
    v_accvgpr_write_b32 a85, v30
    v_accvgpr_write_b32 a93, v31
    v_accvgpr_write_b32 a5, v132
    v_accvgpr_write_b32 a13, v133
    v_accvgpr_write_b32 a21, v134
    v_accvgpr_write_b32 a29, v135
    v_cvt_pk_bf16_f32 v16, v68, v84
    v_cvt_pk_bf16_f32 v17, v69, v85
    v_cvt_pk_bf16_f32 v18, v70, v86
    v_mfma_f32_32x32x16_bf16 v[112:127], v[12:15], v[52:55], v[112:127]
    ds_read_b64_tr_b16 v[44:45], v4 offset:18432
    ds_read_b64_tr_b16 v[46:47], v4 offset:18944
    buffer_load_dwordx4 v3, s[16:19], s60 offen offset:2048  lds
    v_cvt_pk_bf16_f32 v19, v71, v87
    v_cvt_pk_bf16_f32 v20, v72, v88
    v_cvt_pk_bf16_f32 v21, v73, v89
    v_cvt_pk_bf16_f32 v22, v74, v90
    v_cvt_pk_bf16_f32 v23, v75, v91
    v_cvt_pk_bf16_f32 v128, v64, v80
    v_cvt_pk_bf16_f32 v129, v65, v81
    v_cvt_pk_bf16_f32 v130, v66, v82
    v_cvt_pk_bf16_f32 v131, v67, v83
    s_add_u32 m0, s47, 73728
    s_add_u32 s60, s49, 73728
    s_waitcnt lgkmcnt(4)
    v_mfma_f32_32x32x16_bf16 v[64:79], v[8:11], v[32:35], 0
    ds_read_b64_tr_b16 v[48:49], v4 offset:8192
    ds_read_b64_tr_b16 v[50:51], v4 offset:8704
    buffer_load_dwordx4 v2, s[16:19], s60 offen  lds
    v_cvt_pk_bf16_f32 v24, v100, v116
    v_cvt_pk_bf16_f32 v25, v101, v117
    v_cvt_pk_bf16_f32 v26, v102, v118
    v_cvt_pk_bf16_f32 v27, v103, v119
    v_cvt_pk_bf16_f32 v28, v104, v120
    v_cvt_pk_bf16_f32 v29, v105, v121
    v_cvt_pk_bf16_f32 v30, v106, v122
    v_cvt_pk_bf16_f32 v31, v107, v123
    v_cvt_pk_bf16_f32 v132, v96, v112
    v_mfma_f32_32x32x16_bf16 v[64:79], v[12:15], v[36:39], v[64:79]
    ds_read_b64_tr_b16 v[52:53], v4 offset:24576
    ds_read_b64_tr_b16 v[54:55], v4 offset:25088
    buffer_load_dwordx4 v2, s[16:19], s60 offen offset:2048  lds
    v_cvt_pk_bf16_f32 v133, v97, v113
    v_cvt_pk_bf16_f32 v134, v98, v114
    v_cvt_pk_bf16_f32 v135, v99, v115
    v_permlane32_swap_b32_e64 v16, v24
    v_permlane32_swap_b32_e64 v17, v25
    v_permlane32_swap_b32 v18, v26
    s_add_u32 m0, s47, 77824
    s_add_u32 s60, s49, 77824
    s_waitcnt lgkmcnt(4)
    v_mfma_f32_32x32x16_bf16 v[80:95], v[8:11], v[40:43], 0
    ds_read_b64_tr_b16 v[32:33], v4 offset:10240
    ds_read_b64_tr_b16 v[34:35], v4 offset:10752
    buffer_load_dwordx4 v3, s[16:19], s60 offen  lds
    v_permlane32_swap_b32 v19, v27
    v_permlane32_swap_b32 v20, v28
    v_permlane32_swap_b32 v21, v29
    v_permlane32_swap_b32 v22, v30
    v_permlane32_swap_b32_e64 v23, v31
    v_mfma_f32_32x32x16_bf16 v[80:95], v[12:15], v[44:47], v[80:95]
    ds_read_b64_tr_b16 v[36:37], v4 offset:26624
    ds_read_b64_tr_b16 v[38:39], v4 offset:27136
    buffer_load_dwordx4 v3, s[16:19], s60 offen offset:2048  lds
    v_permlane32_swap_b32 v128, v132
    v_permlane32_swap_b32 v129, v133
    v_permlane32_swap_b32 v130, v134
    v_permlane32_swap_b32 v131, v135
    s_add_u32 m0, s47, 98304
    s_add_u32 s60, s50, 65536
    buffer_load_dwordx4 v2, s[16:19], s60 offen  lds
    buffer_load_dwordx4 v2, s[16:19], s60 offen offset:2048  lds
    s_add_u32 m0, s47, 102400
    s_add_u32 s60, s50, 69632
    s_waitcnt vmcnt(10) lgkmcnt(4)
    s_barrier
    v_mfma_f32_32x32x16_bf16 v[96:111], v[8:11], v[48:51], 0
    ds_read_b64_tr_b16 v[40:41], v4 offset:32768
    ds_read_b64_tr_b16 v[42:43], v4 offset:33280
    buffer_load_dwordx4 v3, s[16:19], s60 offen  lds
    v_accvgpr_write_b32 a34, v16
    v_accvgpr_write_b32 a42, v17
    v_accvgpr_write_b32 a50, v18
    v_accvgpr_write_b32 a58, v19
    v_accvgpr_write_b32 a66, v20
    v_accvgpr_write_b32 a74, v21
    v_accvgpr_write_b32 a82, v22
    v_accvgpr_write_b32 a90, v23
    v_accvgpr_write_b32 a2, v128
    v_mfma_f32_32x32x16_bf16 v[96:111], v[12:15], v[52:55], v[96:111]
    ds_read_b64_tr_b16 v[44:45], v4 offset:49152
    ds_read_b64_tr_b16 v[46:47], v4 offset:49664
    buffer_load_dwordx4 v3, s[16:19], s60 offen offset:2048  lds
    v_accvgpr_write_b32 a10, v129
    v_accvgpr_write_b32 a18, v130
    v_accvgpr_write_b32 a26, v131
    v_accvgpr_write_b32 a38, v24
    v_accvgpr_write_b32 a46, v25
    v_accvgpr_write_b32 a54, v26
    v_accvgpr_write_b32 a62, v27
    v_accvgpr_write_b32 a70, v28
    v_accvgpr_write_b32 a78, v29
    s_add_u32 m0, s47, 106496
    s_add_u32 s60, s50, 73728
    s_waitcnt lgkmcnt(4)
    v_mfma_f32_32x32x16_bf16 v[112:127], v[8:11], v[32:35], 0
    ds_read_b64_tr_b16 v[48:49], v4 offset:34816
    ds_read_b64_tr_b16 v[50:51], v4 offset:35328
    buffer_load_dwordx4 v2, s[16:19], s60 offen  lds
    v_accvgpr_write_b32 a86, v30
    v_accvgpr_write_b32 a94, v31
    v_accvgpr_write_b32 a6, v132
    v_accvgpr_write_b32 a14, v133
    v_accvgpr_write_b32 a22, v134
    v_accvgpr_write_b32 a30, v135
    v_cvt_pk_bf16_f32 v16, v68, v84
    v_cvt_pk_bf16_f32 v17, v69, v85
    v_cvt_pk_bf16_f32 v18, v70, v86
    v_mfma_f32_32x32x16_bf16 v[112:127], v[12:15], v[36:39], v[112:127]
    ds_read_b64_tr_b16 v[52:53], v4 offset:51200
    ds_read_b64_tr_b16 v[54:55], v4 offset:51712
    buffer_load_dwordx4 v2, s[16:19], s60 offen offset:2048  lds
    v_cvt_pk_bf16_f32 v19, v71, v87
    v_cvt_pk_bf16_f32 v20, v72, v88
    v_cvt_pk_bf16_f32 v21, v73, v89
    v_cvt_pk_bf16_f32 v22, v74, v90
    v_cvt_pk_bf16_f32 v23, v75, v91
    v_cvt_pk_bf16_f32 v128, v64, v80
    v_cvt_pk_bf16_f32 v129, v65, v81
    v_cvt_pk_bf16_f32 v130, v66, v82
    v_cvt_pk_bf16_f32 v131, v67, v83
    s_add_u32 m0, s47, 110592
    s_add_u32 s60, s50, 77824
    s_waitcnt lgkmcnt(4)
    v_mfma_f32_32x32x16_bf16 v[64:79], v[8:11], v[40:43], 0
    ds_read_b64_tr_b16 v[32:33], v4 offset:40960
    ds_read_b64_tr_b16 v[34:35], v4 offset:41472
    buffer_load_dwordx4 v3, s[16:19], s60 offen  lds
    v_cvt_pk_bf16_f32 v24, v100, v116
    v_cvt_pk_bf16_f32 v25, v101, v117
    v_cvt_pk_bf16_f32 v26, v102, v118
    v_cvt_pk_bf16_f32 v27, v103, v119
    v_cvt_pk_bf16_f32 v28, v104, v120
    v_cvt_pk_bf16_f32 v29, v105, v121
    v_cvt_pk_bf16_f32 v30, v106, v122
    v_cvt_pk_bf16_f32 v31, v107, v123
    v_cvt_pk_bf16_f32 v132, v96, v112
    v_mfma_f32_32x32x16_bf16 v[64:79], v[12:15], v[44:47], v[64:79]
    ds_read_b64_tr_b16 v[36:37], v4 offset:57344
    ds_read_b64_tr_b16 v[38:39], v4 offset:57856
    buffer_load_dwordx4 v3, s[16:19], s60 offen offset:2048  lds
    v_cvt_pk_bf16_f32 v133, v97, v113
    v_cvt_pk_bf16_f32 v134, v98, v114
    v_cvt_pk_bf16_f32 v135, v99, v115
    v_permlane32_swap_b32 v16, v24
    v_permlane32_swap_b32 v17, v25
    v_permlane32_swap_b32 v18, v26
    s_add_u32 m0, s47, 131072
    s_add_u32 s60, s51, 65536
    s_waitcnt lgkmcnt(4)
    v_mfma_f32_32x32x16_bf16 v[80:95], v[8:11], v[48:51], 0
    ds_read_b64_tr_b16 v[40:41], v4 offset:43008
    ds_read_b64_tr_b16 v[42:43], v4 offset:43520
    buffer_load_dwordx4 v2, s[16:19], s60 offen  lds
    v_permlane32_swap_b32_e64 v19, v27
    v_permlane32_swap_b32_e64 v20, v28
    v_permlane32_swap_b32_e64 v21, v29
    v_permlane32_swap_b32_e64 v22, v30
    v_permlane32_swap_b32_e64 v23, v31
    v_mfma_f32_32x32x16_bf16 v[80:95], v[12:15], v[52:55], v[80:95]
    ds_read_b64_tr_b16 v[44:45], v4 offset:59392
    ds_read_b64_tr_b16 v[46:47], v4 offset:59904
    buffer_load_dwordx4 v2, s[16:19], s60 offen offset:2048  lds
    v_permlane32_swap_b32_e64 v128, v132
    v_permlane32_swap_b32_e64 v129, v133
    v_permlane32_swap_b32_e64 v130, v134
    v_permlane32_swap_b32 v131, v135
    s_add_u32 m0, s47, 135168
    s_add_u32 s60, s51, 69632
    buffer_load_dwordx4 v3, s[16:19], s60 offen  lds
    buffer_load_dwordx4 v3, s[16:19], s60 offen offset:2048  lds
    s_add_u32 m0, s47, 139264
    s_add_u32 s60, s51, 73728
    s_waitcnt vmcnt(12) lgkmcnt(4)
    s_barrier
    v_mfma_f32_32x32x16_bf16 v[96:111], v[8:11], v[32:35], 0
    ds_read_b64_tr_b16 v[48:49], v5 offset:0
    ds_read_b64_tr_b16 v[50:51], v5 offset:512
    buffer_load_dwordx4 v2, s[16:19], s60 offen  lds
    v_accvgpr_write_b32 a35, v16
    v_accvgpr_write_b32 a43, v17
    v_accvgpr_write_b32 a51, v18
    v_accvgpr_write_b32 a59, v19
    v_accvgpr_write_b32 a67, v20
    v_accvgpr_write_b32 a75, v21
    v_accvgpr_write_b32 a83, v22
    v_accvgpr_write_b32 a91, v23
    v_accvgpr_write_b32 a3, v128
    v_mfma_f32_32x32x16_bf16 v[96:111], v[12:15], v[36:39], v[96:111]
    ds_read_b64_tr_b16 v[52:53], v5 offset:16384
    ds_read_b64_tr_b16 v[54:55], v5 offset:16896
    buffer_load_dwordx4 v2, s[16:19], s60 offen offset:2048  lds
    v_accvgpr_write_b32 a11, v129
    v_accvgpr_write_b32 a19, v130
    v_accvgpr_write_b32 a27, v131
    v_accvgpr_write_b32 a39, v24
    v_accvgpr_write_b32 a47, v25
    v_accvgpr_write_b32 a55, v26
    v_accvgpr_write_b32 a63, v27
    v_accvgpr_write_b32 a71, v28
    v_accvgpr_write_b32 a79, v29
    s_add_u32 m0, s47, 143360
    s_add_u32 s60, s51, 77824
    s_waitcnt lgkmcnt(4)
    v_mfma_f32_32x32x16_bf16 v[112:127], v[8:11], v[40:43], 0
    ds_read_b64_tr_b16 v[32:33], v5 offset:2048
    ds_read_b64_tr_b16 v[34:35], v5 offset:2560
    buffer_load_dwordx4 v3, s[16:19], s60 offen  lds
    v_accvgpr_write_b32 a87, v30
    v_accvgpr_write_b32 a95, v31
    v_accvgpr_write_b32 a7, v132
    v_accvgpr_write_b32 a15, v133
    v_accvgpr_write_b32 a23, v134
    v_accvgpr_write_b32 a31, v135
    v_cvt_pk_bf16_f32 v16, v68, v84
    v_cvt_pk_bf16_f32 v17, v69, v85
    v_cvt_pk_bf16_f32 v18, v70, v86
    v_mfma_f32_32x32x16_bf16 v[112:127], v[12:15], v[44:47], v[112:127]
    ds_read_b64_tr_b16 v[36:37], v5 offset:18432
    ds_read_b64_tr_b16 v[38:39], v5 offset:18944
    buffer_load_dwordx4 v3, s[16:19], s60 offen offset:2048  lds
    v_cvt_pk_bf16_f32 v19, v71, v87
    v_cvt_pk_bf16_f32 v20, v72, v88
    v_cvt_pk_bf16_f32 v21, v73, v89
    v_cvt_pk_bf16_f32 v22, v74, v90
    v_cvt_pk_bf16_f32 v23, v75, v91
    v_cvt_pk_bf16_f32 v128, v64, v80
    v_cvt_pk_bf16_f32 v129, v65, v81
    v_cvt_pk_bf16_f32 v130, v66, v82
    v_cvt_pk_bf16_f32 v131, v67, v83
    s_add_u32 m0, s47, 0
    s_add_u32 s60, s48, 131072
    buffer_load_dwordx4 v2, s[16:19], s60 offen  lds
    buffer_load_dwordx4 v2, s[16:19], s60 offen offset:2048  lds
    s_add_u32 m0, s47, 4096
    s_add_u32 s60, s48, 135168
    s_waitcnt lgkmcnt(4)
    v_mfma_f32_32x32x16_bf16 v[64:79], v[8:11], v[48:51], 0
    ds_read_b64_tr_b16 v[40:41], v5 offset:8192
    ds_read_b64_tr_b16 v[42:43], v5 offset:8704
    buffer_load_dwordx4 v3, s[16:19], s60 offen  lds
    v_cvt_pk_bf16_f32 v24, v100, v116
    v_cvt_pk_bf16_f32 v25, v101, v117
    v_cvt_pk_bf16_f32 v26, v102, v118
    v_cvt_pk_bf16_f32 v27, v103, v119
    v_cvt_pk_bf16_f32 v28, v104, v120
    v_cvt_pk_bf16_f32 v29, v105, v121
    v_cvt_pk_bf16_f32 v30, v106, v122
    v_cvt_pk_bf16_f32 v31, v107, v123
    v_cvt_pk_bf16_f32 v132, v96, v112
    v_mfma_f32_32x32x16_bf16 v[64:79], v[12:15], v[52:55], v[64:79]
    ds_read_b64_tr_b16 v[44:45], v5 offset:24576
    ds_read_b64_tr_b16 v[46:47], v5 offset:25088
    buffer_load_dwordx4 v3, s[16:19], s60 offen offset:2048  lds
    v_cvt_pk_bf16_f32 v133, v97, v113
    v_cvt_pk_bf16_f32 v134, v98, v114
    v_cvt_pk_bf16_f32 v135, v99, v115
    v_permlane32_swap_b32 v16, v24
    v_permlane32_swap_b32 v17, v25
    v_permlane32_swap_b32 v18, v26
    s_add_u32 m0, s47, 8192
    s_add_u32 s60, s48, 139264
    s_waitcnt lgkmcnt(4)
    v_mfma_f32_32x32x16_bf16 v[80:95], v[8:11], v[32:35], 0
    ds_read_b64_tr_b16 v[48:49], v5 offset:10240
    ds_read_b64_tr_b16 v[50:51], v5 offset:10752
    buffer_load_dwordx4 v2, s[16:19], s60 offen  lds
    v_permlane32_swap_b32_e64 v19, v27
    v_permlane32_swap_b32 v20, v28
    v_permlane32_swap_b32 v21, v29
    v_permlane32_swap_b32 v22, v30
    v_permlane32_swap_b32 v23, v31
    v_mfma_f32_32x32x16_bf16 v[80:95], v[12:15], v[36:39], v[80:95]
    ds_read_b64_tr_b16 v[52:53], v5 offset:26624
    ds_read_b64_tr_b16 v[54:55], v5 offset:27136
    buffer_load_dwordx4 v2, s[16:19], s60 offen offset:2048  lds
    v_permlane32_swap_b32 v128, v132
    v_permlane32_swap_b32 v129, v133
    v_permlane32_swap_b32 v130, v134
    v_permlane32_swap_b32 v131, v135
    s_add_u32 m0, s47, 12288
    s_add_u32 s60, s48, 143360
    buffer_load_dwordx4 v3, s[16:19], s60 offen  lds
    buffer_load_dwordx4 v3, s[16:19], s60 offen offset:2048  lds
    s_waitcnt vmcnt(16) lgkmcnt(4)
    s_barrier
    v_mfma_f32_32x32x16_bf16 v[96:111], v[8:11], v[40:43], 0
    ds_read_b64_tr_b16 v[32:33], v5 offset:32768
    ds_read_b64_tr_b16 v[34:35], v5 offset:33280
    v_accvgpr_write_b32 a128, v16
    v_accvgpr_write_b32 a136, v17
    v_accvgpr_write_b32 a144, v18
    v_accvgpr_write_b32 a152, v19
    v_accvgpr_write_b32 a160, v20
    v_accvgpr_write_b32 a168, v21
    v_accvgpr_write_b32 a176, v22
    v_accvgpr_write_b32 a184, v23
    v_accvgpr_write_b32 a96, v128
    v_mfma_f32_32x32x16_bf16 v[96:111], v[12:15], v[44:47], v[96:111]
    ds_read_b64_tr_b16 v[36:37], v5 offset:49152
    ds_read_b64_tr_b16 v[38:39], v5 offset:49664
    v_accvgpr_write_b32 a104, v129
    v_accvgpr_write_b32 a112, v130
    v_accvgpr_write_b32 a120, v131
    v_accvgpr_write_b32 a132, v24
    v_accvgpr_write_b32 a140, v25
    v_accvgpr_write_b32 a148, v26
    v_accvgpr_write_b32 a156, v27
    v_accvgpr_write_b32 a164, v28
    v_accvgpr_write_b32 a172, v29
    s_waitcnt lgkmcnt(4)
    v_mfma_f32_32x32x16_bf16 v[112:127], v[8:11], v[48:51], 0
    ds_read_b64_tr_b16 v[40:41], v5 offset:34816
    ds_read_b64_tr_b16 v[42:43], v5 offset:35328
    v_accvgpr_write_b32 a180, v30
    v_accvgpr_write_b32 a188, v31
    v_accvgpr_write_b32 a100, v132
    v_accvgpr_write_b32 a108, v133
    v_accvgpr_write_b32 a116, v134
    v_accvgpr_write_b32 a124, v135
    v_cvt_pk_bf16_f32 v16, v68, v84
    v_cvt_pk_bf16_f32 v17, v69, v85
    v_cvt_pk_bf16_f32 v18, v70, v86
    v_mfma_f32_32x32x16_bf16 v[112:127], v[12:15], v[52:55], v[112:127]
    ds_read_b64_tr_b16 v[44:45], v5 offset:51200
    ds_read_b64_tr_b16 v[46:47], v5 offset:51712
    v_cvt_pk_bf16_f32 v19, v71, v87
    v_cvt_pk_bf16_f32 v20, v72, v88
    v_cvt_pk_bf16_f32 v21, v73, v89
    v_cvt_pk_bf16_f32 v22, v74, v90
    v_cvt_pk_bf16_f32 v23, v75, v91
    v_cvt_pk_bf16_f32 v128, v64, v80
    v_cvt_pk_bf16_f32 v129, v65, v81
    v_cvt_pk_bf16_f32 v130, v66, v82
    v_cvt_pk_bf16_f32 v131, v67, v83
    s_waitcnt lgkmcnt(4)
    v_mfma_f32_32x32x16_bf16 v[64:79], v[8:11], v[32:35], 0
    ds_read_b64_tr_b16 v[48:49], v5 offset:40960
    ds_read_b64_tr_b16 v[50:51], v5 offset:41472
    v_cvt_pk_bf16_f32 v24, v100, v116
    v_cvt_pk_bf16_f32 v25, v101, v117
    v_cvt_pk_bf16_f32 v26, v102, v118
    v_cvt_pk_bf16_f32 v27, v103, v119
    v_cvt_pk_bf16_f32 v28, v104, v120
    v_cvt_pk_bf16_f32 v29, v105, v121
    v_cvt_pk_bf16_f32 v30, v106, v122
    v_cvt_pk_bf16_f32 v31, v107, v123
    v_cvt_pk_bf16_f32 v132, v96, v112
    v_mfma_f32_32x32x16_bf16 v[64:79], v[12:15], v[36:39], v[64:79]
    ds_read_b64_tr_b16 v[52:53], v5 offset:57344
    ds_read_b64_tr_b16 v[54:55], v5 offset:57856
    v_cvt_pk_bf16_f32 v133, v97, v113
    v_cvt_pk_bf16_f32 v134, v98, v114
    v_cvt_pk_bf16_f32 v135, v99, v115
    v_permlane32_swap_b32 v16, v24
    v_permlane32_swap_b32 v17, v25
    v_permlane32_swap_b32 v18, v26
    s_waitcnt lgkmcnt(4)
    v_mfma_f32_32x32x16_bf16 v[80:95], v[8:11], v[40:43], 0
    ds_read_b64_tr_b16 v[32:33], v5 offset:43008
    ds_read_b64_tr_b16 v[34:35], v5 offset:43520
    v_permlane32_swap_b32 v19, v27
    v_permlane32_swap_b32 v20, v28
    v_permlane32_swap_b32 v21, v29
    v_permlane32_swap_b32 v22, v30
    v_permlane32_swap_b32 v23, v31
    v_mfma_f32_32x32x16_bf16 v[80:95], v[12:15], v[44:47], v[80:95]
    ds_read_b64_tr_b16 v[36:37], v5 offset:59392
    ds_read_b64_tr_b16 v[38:39], v5 offset:59904
    v_permlane32_swap_b32 v128, v132
    v_permlane32_swap_b32 v129, v133
    v_permlane32_swap_b32 v130, v134
    v_permlane32_swap_b32_e64 v131, v135
    s_add_u32 m0, s47, 32768
    s_add_u32 s60, s49, 131072
    s_waitcnt vmcnt(8) lgkmcnt(4)
    s_barrier
    v_mfma_f32_32x32x16_bf16 v[96:111], v[8:11], v[48:51], 0
    ds_read_b64_tr_b16 v[40:41], v56 offset:0
    ds_read_b64_tr_b16 v[42:43], v56 offset:512
    buffer_load_dwordx4 v2, s[16:19], s60 offen  lds
    v_accvgpr_write_b32 a129, v16
    v_accvgpr_write_b32 a137, v17
    v_accvgpr_write_b32 a145, v18
    v_accvgpr_write_b32 a153, v19
    v_accvgpr_write_b32 a161, v20
    v_accvgpr_write_b32 a169, v21
    v_accvgpr_write_b32 a177, v22
    v_accvgpr_write_b32 a185, v23
    v_accvgpr_write_b32 a97, v128
    v_mfma_f32_32x32x16_bf16 v[96:111], v[12:15], v[52:55], v[96:111]
    ds_read_b64_tr_b16 v[44:45], v56 offset:16384
    ds_read_b64_tr_b16 v[46:47], v56 offset:16896
    buffer_load_dwordx4 v2, s[16:19], s60 offen offset:2048  lds
    v_accvgpr_write_b32 a105, v129
    v_accvgpr_write_b32 a113, v130
    v_accvgpr_write_b32 a121, v131
    v_accvgpr_write_b32 a133, v24
    v_accvgpr_write_b32 a141, v25
    v_accvgpr_write_b32 a149, v26
    v_accvgpr_write_b32 a157, v27
    v_accvgpr_write_b32 a165, v28
    v_accvgpr_write_b32 a173, v29
    s_add_u32 m0, s47, 36864
    s_add_u32 s60, s49, 135168
    s_waitcnt lgkmcnt(4)
    v_mfma_f32_32x32x16_bf16 v[112:127], v[8:11], v[32:35], 0
    ds_read_b64_tr_b16 v[48:49], v56 offset:2048
    ds_read_b64_tr_b16 v[50:51], v56 offset:2560
    buffer_load_dwordx4 v3, s[16:19], s60 offen  lds
    v_accvgpr_write_b32 a181, v30
    v_accvgpr_write_b32 a189, v31
    v_accvgpr_write_b32 a101, v132
    v_accvgpr_write_b32 a109, v133
    v_accvgpr_write_b32 a117, v134
    v_accvgpr_write_b32 a125, v135
    v_cvt_pk_bf16_f32 v16, v68, v84
    v_cvt_pk_bf16_f32 v17, v69, v85
    v_cvt_pk_bf16_f32 v18, v70, v86
    v_mfma_f32_32x32x16_bf16 v[112:127], v[12:15], v[36:39], v[112:127]
    ds_read_b64_tr_b16 v[52:53], v56 offset:18432
    ds_read_b64_tr_b16 v[54:55], v56 offset:18944
    buffer_load_dwordx4 v3, s[16:19], s60 offen offset:2048  lds
    v_cvt_pk_bf16_f32 v19, v71, v87
    v_cvt_pk_bf16_f32 v20, v72, v88
    v_cvt_pk_bf16_f32 v21, v73, v89
    v_cvt_pk_bf16_f32 v22, v74, v90
    v_cvt_pk_bf16_f32 v23, v75, v91
    v_cvt_pk_bf16_f32 v128, v64, v80
    v_cvt_pk_bf16_f32 v129, v65, v81
    v_cvt_pk_bf16_f32 v130, v66, v82
    v_cvt_pk_bf16_f32 v131, v67, v83
    s_add_u32 m0, s47, 40960
    s_add_u32 s60, s49, 139264
    s_waitcnt lgkmcnt(4)
    v_mfma_f32_32x32x16_bf16 v[64:79], v[8:11], v[40:43], 0
    ds_read_b64_tr_b16 v[32:33], v56 offset:8192
    ds_read_b64_tr_b16 v[34:35], v56 offset:8704
    buffer_load_dwordx4 v2, s[16:19], s60 offen  lds
    v_cvt_pk_bf16_f32 v24, v100, v116
    v_cvt_pk_bf16_f32 v25, v101, v117
    v_cvt_pk_bf16_f32 v26, v102, v118
    v_cvt_pk_bf16_f32 v27, v103, v119
    v_cvt_pk_bf16_f32 v28, v104, v120
    v_cvt_pk_bf16_f32 v29, v105, v121
    v_cvt_pk_bf16_f32 v30, v106, v122
    v_cvt_pk_bf16_f32 v31, v107, v123
    v_cvt_pk_bf16_f32 v132, v96, v112
    v_mfma_f32_32x32x16_bf16 v[64:79], v[12:15], v[44:47], v[64:79]
    ds_read_b64_tr_b16 v[36:37], v56 offset:24576
    ds_read_b64_tr_b16 v[38:39], v56 offset:25088
    buffer_load_dwordx4 v2, s[16:19], s60 offen offset:2048  lds
    v_cvt_pk_bf16_f32 v133, v97, v113
    v_cvt_pk_bf16_f32 v134, v98, v114
    v_cvt_pk_bf16_f32 v135, v99, v115
    v_permlane32_swap_b32_e64 v16, v24
    v_permlane32_swap_b32_e64 v17, v25
    v_permlane32_swap_b32 v18, v26
    s_add_u32 m0, s47, 45056
    s_add_u32 s60, s49, 143360
    s_waitcnt lgkmcnt(4)
    v_mfma_f32_32x32x16_bf16 v[80:95], v[8:11], v[48:51], 0
    ds_read_b64_tr_b16 v[40:41], v56 offset:10240
    ds_read_b64_tr_b16 v[42:43], v56 offset:10752
    buffer_load_dwordx4 v3, s[16:19], s60 offen  lds
    v_permlane32_swap_b32 v19, v27
    v_permlane32_swap_b32 v20, v28
    v_permlane32_swap_b32 v21, v29
    v_permlane32_swap_b32 v22, v30
    v_permlane32_swap_b32_e64 v23, v31
    v_mfma_f32_32x32x16_bf16 v[80:95], v[12:15], v[52:55], v[80:95]
    ds_read_b64_tr_b16 v[44:45], v56 offset:26624
    ds_read_b64_tr_b16 v[46:47], v56 offset:27136
    buffer_load_dwordx4 v3, s[16:19], s60 offen offset:2048  lds
    v_permlane32_swap_b32_e64 v128, v132
    v_permlane32_swap_b32_e64 v129, v133
    v_permlane32_swap_b32 v130, v134
    v_permlane32_swap_b32_e64 v131, v135
    s_add_u32 m0, s47, 65536
    s_add_u32 s60, s50, 131072
    buffer_load_dwordx4 v2, s[16:19], s60 offen  lds
    buffer_load_dwordx4 v2, s[16:19], s60 offen offset:2048  lds
    s_add_u32 m0, s47, 69632
    s_add_u32 s60, s50, 135168
    s_waitcnt vmcnt(10) lgkmcnt(4)
Lpg2:
    s_cbranch_execz Lpg6
    s_barrier
    v_mfma_f32_32x32x16_bf16 v[96:111], v[8:11], v[32:35], 0
    ds_read_b64_tr_b16 v[48:49], v4 offset:0
    ds_read_b64_tr_b16 v[50:51], v4 offset:512
    buffer_load_dwordx4 v3, s[16:19], s60 offen  lds
    v_accvgpr_write_b32 a130, v16
    v_accvgpr_write_b32 a138, v17
    v_accvgpr_write_b32 a146, v18
    v_accvgpr_write_b32 a154, v19
    v_accvgpr_write_b32 a162, v20
    v_accvgpr_write_b32 a170, v21
    v_accvgpr_write_b32 a178, v22
    v_accvgpr_write_b32 a186, v23
    v_accvgpr_write_b32 a98, v128
    v_mfma_f32_32x32x16_bf16 v[96:111], v[12:15], v[36:39], v[96:111]
    ds_read_b64_tr_b16 v[52:53], v4 offset:16384
    ds_read_b64_tr_b16 v[54:55], v4 offset:16896
    buffer_load_dwordx4 v3, s[16:19], s60 offen offset:2048  lds
    v_accvgpr_write_b32 a106, v129
    v_accvgpr_write_b32 a114, v130
    v_accvgpr_write_b32 a122, v131
    v_accvgpr_write_b32 a134, v24
    v_accvgpr_write_b32 a142, v25
    v_accvgpr_write_b32 a150, v26
    v_accvgpr_write_b32 a158, v27
    v_accvgpr_write_b32 a166, v28
    v_accvgpr_write_b32 a174, v29
    s_add_u32 m0, s47, 73728
    s_add_u32 s60, s50, 139264
    s_waitcnt lgkmcnt(4)
    v_mfma_f32_32x32x16_bf16 v[112:127], v[8:11], v[40:43], 0
    ds_read_b64_tr_b16 v[32:33], v4 offset:2048
    ds_read_b64_tr_b16 v[34:35], v4 offset:2560
    buffer_load_dwordx4 v2, s[16:19], s60 offen  lds
    v_accvgpr_write_b32 a182, v30
    v_accvgpr_write_b32 a190, v31
    v_accvgpr_write_b32 a102, v132
    v_accvgpr_write_b32 a110, v133
    v_accvgpr_write_b32 a118, v134
    v_accvgpr_write_b32 a126, v135
    v_cvt_pk_bf16_f32 v16, v68, v84
    v_cvt_pk_bf16_f32 v17, v69, v85
    v_cvt_pk_bf16_f32 v18, v70, v86
    v_mfma_f32_32x32x16_bf16 v[112:127], v[12:15], v[44:47], v[112:127]
    ds_read_b64_tr_b16 v[36:37], v4 offset:18432
    ds_read_b64_tr_b16 v[38:39], v4 offset:18944
    buffer_load_dwordx4 v2, s[16:19], s60 offen offset:2048  lds
    v_cvt_pk_bf16_f32 v19, v71, v87
    v_cvt_pk_bf16_f32 v20, v72, v88
    v_cvt_pk_bf16_f32 v21, v73, v89
    v_cvt_pk_bf16_f32 v22, v74, v90
    v_cvt_pk_bf16_f32 v23, v75, v91
    v_cvt_pk_bf16_f32 v128, v64, v80
    v_cvt_pk_bf16_f32 v129, v65, v81
    v_cvt_pk_bf16_f32 v130, v66, v82
    v_cvt_pk_bf16_f32 v131, v67, v83
    s_add_u32 m0, s47, 77824
    s_add_u32 s60, s50, 143360
    s_waitcnt lgkmcnt(4)
    v_mfma_f32_32x32x16_bf16 v[64:79], v[8:11], v[48:51], 0
    ds_read_b64_tr_b16 v[40:41], v4 offset:8192
    ds_read_b64_tr_b16 v[42:43], v4 offset:8704
    buffer_load_dwordx4 v3, s[16:19], s60 offen  lds
    v_cvt_pk_bf16_f32 v24, v100, v116
    v_cvt_pk_bf16_f32 v25, v101, v117
    v_cvt_pk_bf16_f32 v26, v102, v118
    v_cvt_pk_bf16_f32 v27, v103, v119
    v_cvt_pk_bf16_f32 v28, v104, v120
    v_cvt_pk_bf16_f32 v29, v105, v121
    v_cvt_pk_bf16_f32 v30, v106, v122
    v_cvt_pk_bf16_f32 v31, v107, v123
    v_cvt_pk_bf16_f32 v132, v96, v112
    v_mfma_f32_32x32x16_bf16 v[64:79], v[12:15], v[52:55], v[64:79]
    ds_read_b64_tr_b16 v[44:45], v4 offset:24576
    ds_read_b64_tr_b16 v[46:47], v4 offset:25088
    buffer_load_dwordx4 v3, s[16:19], s60 offen offset:2048  lds
    v_cvt_pk_bf16_f32 v133, v97, v113
    v_cvt_pk_bf16_f32 v134, v98, v114
    v_cvt_pk_bf16_f32 v135, v99, v115
    v_permlane32_swap_b32_e64 v16, v24
    v_permlane32_swap_b32_e64 v17, v25
    v_permlane32_swap_b32 v18, v26
    s_add_u32 m0, s47, 98304
    s_add_u32 s60, s51, 131072
    s_waitcnt lgkmcnt(4)
    v_mfma_f32_32x32x16_bf16 v[80:95], v[8:11], v[32:35], 0
    ds_read_b64_tr_b16 v[48:49], v4 offset:10240
    ds_read_b64_tr_b16 v[50:51], v4 offset:10752
    buffer_load_dwordx4 v2, s[16:19], s60 offen  lds
    v_permlane32_swap_b32 v19, v27
    v_permlane32_swap_b32 v20, v28
    v_permlane32_swap_b32 v21, v29
    v_permlane32_swap_b32 v22, v30
    v_permlane32_swap_b32_e64 v23, v31
    v_mfma_f32_32x32x16_bf16 v[80:95], v[12:15], v[36:39], v[80:95]
    ds_read_b64_tr_b16 v[52:53], v4 offset:26624
    ds_read_b64_tr_b16 v[54:55], v4 offset:27136
    buffer_load_dwordx4 v2, s[16:19], s60 offen offset:2048  lds
    v_permlane32_swap_b32 v128, v132
    v_permlane32_swap_b32 v129, v133
    v_permlane32_swap_b32_e64 v130, v134
    v_permlane32_swap_b32_e64 v131, v135
    s_add_u32 m0, s47, 102400
    s_add_u32 s60, s51, 135168
    buffer_load_dwordx4 v3, s[16:19], s60 offen  lds
    buffer_load_dwordx4 v3, s[16:19], s60 offen offset:2048  lds
    s_add_u32 m0, s47, 106496
    s_add_u32 s60, s51, 139264
    s_waitcnt vmcnt(12) lgkmcnt(4)
    s_barrier
    v_mfma_f32_32x32x16_bf16 v[96:111], v[8:11], v[40:43], 0
    ds_read_b64_tr_b16 v[32:33], v4 offset:32768
    ds_read_b64_tr_b16 v[34:35], v4 offset:33280
    buffer_load_dwordx4 v2, s[16:19], s60 offen  lds
    v_accvgpr_write_b32 a131, v16
    v_accvgpr_write_b32 a139, v17
    v_accvgpr_write_b32 a147, v18
    v_accvgpr_write_b32 a155, v19
    v_accvgpr_write_b32 a163, v20
    v_accvgpr_write_b32 a171, v21
    v_accvgpr_write_b32 a179, v22
    v_accvgpr_write_b32 a187, v23
    v_accvgpr_write_b32 a99, v128
    v_mfma_f32_32x32x16_bf16 v[96:111], v[12:15], v[44:47], v[96:111]
    ds_read_b64_tr_b16 v[36:37], v4 offset:49152
    ds_read_b64_tr_b16 v[38:39], v4 offset:49664
    buffer_load_dwordx4 v2, s[16:19], s60 offen offset:2048  lds
    v_accvgpr_write_b32 a107, v129
    v_accvgpr_write_b32 a115, v130
    v_accvgpr_write_b32 a123, v131
    v_accvgpr_write_b32 a135, v24
    v_accvgpr_write_b32 a143, v25
    v_accvgpr_write_b32 a151, v26
    v_accvgpr_write_b32 a159, v27
    v_accvgpr_write_b32 a167, v28
    v_accvgpr_write_b32 a175, v29
    s_add_u32 m0, s47, 110592
    s_add_u32 s60, s51, 143360
    s_waitcnt lgkmcnt(4)
    v_mfma_f32_32x32x16_bf16 v[112:127], v[8:11], v[48:51], 0
    ds_read_b64_tr_b16 v[40:41], v4 offset:34816
    ds_read_b64_tr_b16 v[42:43], v4 offset:35328
    buffer_load_dword v7, v57, s[28:31], 0 offen sc1
    global_load_dword v61, v[62:63], off
    buffer_load_dwordx4 v3, s[16:19], s60 offen  lds
    v_accvgpr_write_b32 a183, v30
    v_accvgpr_write_b32 a191, v31
    v_accvgpr_write_b32 a103, v132
    v_accvgpr_write_b32 a111, v133
    v_accvgpr_write_b32 a119, v134
    v_accvgpr_write_b32 a127, v135
    v_cvt_pk_bf16_f32 v16, v68, v84
    v_cvt_pk_bf16_f32 v17, v69, v85
    v_cvt_pk_bf16_f32 v18, v70, v86
    v_mfma_f32_32x32x16_bf16 v[112:127], v[12:15], v[52:55], v[112:127]
    ds_read_b64_tr_b16 v[44:45], v4 offset:51200
    ds_read_b64_tr_b16 v[46:47], v4 offset:51712
    buffer_load_dwordx4 v3, s[16:19], s60 offen offset:2048  lds
    v_cvt_pk_bf16_f32 v19, v71, v87
    v_cvt_pk_bf16_f32 v20, v72, v88
    v_cvt_pk_bf16_f32 v21, v73, v89
    v_cvt_pk_bf16_f32 v22, v74, v90
    v_cvt_pk_bf16_f32 v23, v75, v91
    v_cvt_pk_bf16_f32 v224, v64, v80
    v_cvt_pk_bf16_f32 v232, v65, v81
    v_cvt_pk_bf16_f32 v240, v66, v82
    v_cvt_pk_bf16_f32 v248, v67, v83
    s_add_u32 m0, s47, 131072
    s_add_u32 s60, s48, 196608
    buffer_load_dwordx4 v2, s[16:19], s60 offen  lds
    buffer_load_dwordx4 v2, s[16:19], s60 offen offset:2048  lds
    s_add_u32 m0, s47, 135168
    s_add_u32 s60, s48, 200704
    s_waitcnt lgkmcnt(4)
    v_mfma_f32_32x32x16_bf16 v[64:79], v[8:11], v[32:35], 0
    ds_read_b64_tr_b16 v[48:49], v4 offset:40960
    ds_read_b64_tr_b16 v[50:51], v4 offset:41472
    buffer_load_dwordx4 v3, s[16:19], s60 offen  lds
    v_cvt_pk_bf16_f32 v24, v100, v116
    v_cvt_pk_bf16_f32 v25, v101, v117
    v_cvt_pk_bf16_f32 v26, v102, v118
    v_cvt_pk_bf16_f32 v27, v103, v119
    v_cvt_pk_bf16_f32 v28, v104, v120
    v_cvt_pk_bf16_f32 v29, v105, v121
    v_cvt_pk_bf16_f32 v30, v106, v122
    v_cvt_pk_bf16_f32 v31, v107, v123
    v_mfma_f32_32x32x16_bf16 v[64:79], v[12:15], v[36:39], v[64:79]
    ds_read_b64_tr_b16 v[52:53], v4 offset:57344
    ds_read_b64_tr_b16 v[54:55], v4 offset:57856
    buffer_load_dwordx4 v3, s[16:19], s60 offen offset:2048  lds
    v_cvt_pk_bf16_f32 v228, v96, v112
    v_cvt_pk_bf16_f32 v236, v97, v113
    v_cvt_pk_bf16_f32 v244, v98, v114
    v_cvt_pk_bf16_f32 v252, v99, v115
    v_permlane32_swap_b32_e64 v16, v24
    v_permlane32_swap_b32 v17, v25
    s_add_u32 m0, s47, 139264
    s_add_u32 s60, s48, 204800
    s_waitcnt lgkmcnt(4)
    v_mfma_f32_32x32x16_bf16 v[80:95], v[8:11], v[40:43], 0
    ds_read_b64_tr_b16 v[32:33], v4 offset:43008
    ds_read_b64_tr_b16 v[34:35], v4 offset:43520
    buffer_load_dwordx4 v2, s[16:19], s60 offen  lds
    v_permlane32_swap_b32 v18, v26
    v_permlane32_swap_b32 v19, v27
    v_permlane32_swap_b32 v20, v28
    v_permlane32_swap_b32 v21, v29
    v_mfma_f32_32x32x16_bf16 v[80:95], v[12:15], v[44:47], v[80:95]
    ds_read_b64_tr_b16 v[36:37], v4 offset:59392
    ds_read_b64_tr_b16 v[38:39], v4 offset:59904
    buffer_load_dwordx4 v2, s[16:19], s60 offen offset:2048  lds
    v_permlane32_swap_b32 v22, v30
    v_permlane32_swap_b32 v23, v31
    v_permlane32_swap_b32 v224, v228
    v_permlane32_swap_b32 v232, v236
    s_add_u32 m0, s47, 143360
    s_add_u32 s60, s48, 208896
    buffer_load_dwordx4 v3, s[16:19], s60 offen  lds
    buffer_load_dwordx4 v3, s[16:19], s60 offen offset:2048  lds
    s_waitcnt vmcnt(18) lgkmcnt(4)
    s_barrier
    v_mfma_f32_32x32x16_bf16 v[96:111], v[8:11], v[48:51], 0
    ds_read_b64_tr_b16 v[40:41], v5 offset:0
    ds_read_b64_tr_b16 v[42:43], v5 offset:512
    s_or_b32 s52, s86, s44
    s_cbranch_scc1 Lnowt
    s_lshl_b32 s52, s43, 17
    s_lshl_b32 s53, s45, 15
    s_add_u32 s52, s52, s53
    v_lshlrev_b32 v58, 7, v0
    buffer_load_dword v61, v58, s[32:35], s52 offen
Lnowt:
    buffer_load_dword v61, v60, s[16:19], s96 offen
    v_accvgpr_write_b32 a192, v16
    v_accvgpr_write_b32 a200, v17
    v_accvgpr_write_b32 a208, v18
    v_accvgpr_write_b32 a216, v19
    v_accvgpr_write_b32 a224, v20
    v_accvgpr_write_b32 a232, v21
    v_permlane32_swap_b32_e64 v240, v244
    v_mfma_f32_32x32x16_bf16 v[96:111], v[12:15], v[52:55], v[96:111]
    ds_read_b64_tr_b16 v[44:45], v5 offset:16384
    ds_read_b64_tr_b16 v[46:47], v5 offset:16896
    v_permlane32_swap_b32_e64 v248, v252
    v_accvgpr_write_b32 a240, v22
    v_accvgpr_write_b32 a248, v23
    v_accvgpr_write_b32 a196, v24
    v_accvgpr_write_b32 a204, v25
    v_accvgpr_write_b32 a212, v26
    v_accvgpr_write_b32 a220, v27
    s_waitcnt lgkmcnt(4)
    v_mfma_f32_32x32x16_bf16 v[112:127], v[8:11], v[32:35], 0
    ds_read_b64_tr_b16 v[48:49], v5 offset:2048
    ds_read_b64_tr_b16 v[50:51], v5 offset:2560
    v_accvgpr_write_b32 a228, v28
    v_accvgpr_write_b32 a236, v29
    v_accvgpr_write_b32 a244, v30
    v_accvgpr_write_b32 a252, v31
    v_cvt_pk_bf16_f32 v16, v68, v84
    v_cvt_pk_bf16_f32 v17, v69, v85
    v_cvt_pk_bf16_f32 v18, v70, v86
    v_cvt_pk_bf16_f32 v19, v71, v87
    v_mfma_f32_32x32x16_bf16 v[112:127], v[12:15], v[36:39], v[112:127]
    ds_read_b64_tr_b16 v[52:53], v5 offset:18432
    ds_read_b64_tr_b16 v[54:55], v5 offset:18944
    v_cvt_pk_bf16_f32 v20, v72, v88
    v_cvt_pk_bf16_f32 v21, v73, v89
    v_cvt_pk_bf16_f32 v22, v74, v90
    v_cvt_pk_bf16_f32 v23, v75, v91
    v_cvt_pk_bf16_f32 v225, v64, v80
    v_cvt_pk_bf16_f32 v233, v65, v81
    v_cvt_pk_bf16_f32 v241, v66, v82
    v_cvt_pk_bf16_f32 v249, v67, v83
    s_waitcnt lgkmcnt(4)
    v_mfma_f32_32x32x16_bf16 v[64:79], v[8:11], v[40:43], 0
    ds_read_b64_tr_b16 v[32:33], v5 offset:8192
    ds_read_b64_tr_b16 v[34:35], v5 offset:8704
    v_cvt_pk_bf16_f32 v24, v100, v116
    v_cvt_pk_bf16_f32 v25, v101, v117
    v_cvt_pk_bf16_f32 v26, v102, v118
    v_cvt_pk_bf16_f32 v27, v103, v119
    v_cvt_pk_bf16_f32 v28, v104, v120
    v_cvt_pk_bf16_f32 v29, v105, v121
    v_cvt_pk_bf16_f32 v30, v106, v122
    v_cvt_pk_bf16_f32 v31, v107, v123
    v_mfma_f32_32x32x16_bf16 v[64:79], v[12:15], v[44:47], v[64:79]
    ds_read_b64_tr_b16 v[36:37], v5 offset:24576
    ds_read_b64_tr_b16 v[38:39], v5 offset:25088
    v_cvt_pk_bf16_f32 v229, v96, v112
    v_cvt_pk_bf16_f32 v237, v97, v113
    v_cvt_pk_bf16_f32 v245, v98, v114
    v_cvt_pk_bf16_f32 v253, v99, v115
    v_permlane32_swap_b32_e64 v16, v24
    v_permlane32_swap_b32 v17, v25
    s_waitcnt lgkmcnt(4)
    v_mfma_f32_32x32x16_bf16 v[80:95], v[8:11], v[48:51], 0
    ds_read_b64_tr_b16 v[40:41], v5 offset:10240
    ds_read_b64_tr_b16 v[42:43], v5 offset:10752
    v_permlane32_swap_b32 v18, v26
    v_permlane32_swap_b32 v19, v27
    v_permlane32_swap_b32 v20, v28
    v_permlane32_swap_b32 v21, v29
    v_mfma_f32_32x32x16_bf16 v[80:95], v[12:15], v[52:55], v[80:95]
    ds_read_b64_tr_b16 v[44:45], v5 offset:26624
    ds_read_b64_tr_b16 v[46:47], v5 offset:27136
    v_permlane32_swap_b32 v22, v30
    v_permlane32_swap_b32 v23, v31
    v_permlane32_swap_b32 v225, v229
    v_permlane32_swap_b32_e64 v233, v237
    s_add_u32 m0, s47, 0
    s_add_u32 s60, s49, 196608
    s_waitcnt vmcnt(9) lgkmcnt(4)
    s_barrier
    v_mfma_f32_32x32x16_bf16 v[96:111], v[8:11], v[32:35], 0
    ds_read_b64_tr_b16 v[48:49], v5 offset:32768
    ds_read_b64_tr_b16 v[50:51], v5 offset:33280
    buffer_load_dwordx4 v2, s[16:19], s60 offen  lds
    v_accvgpr_write_b32 a193, v16
    v_accvgpr_write_b32 a201, v17
    v_accvgpr_write_b32 a209, v18
    v_accvgpr_write_b32 a217, v19
    v_accvgpr_write_b32 a225, v20
    v_accvgpr_write_b32 a233, v21
    v_permlane32_swap_b32_e64 v241, v245
    v_mfma_f32_32x32x16_bf16 v[96:111], v[12:15], v[36:39], v[96:111]
    ds_read_b64_tr_b16 v[52:53], v5 offset:49152
    ds_read_b64_tr_b16 v[54:55], v5 offset:49664
    buffer_load_dwordx4 v2, s[16:19], s60 offen offset:2048  lds
    v_permlane32_swap_b32_e64 v249, v253
    v_accvgpr_write_b32 a241, v22
    v_accvgpr_write_b32 a249, v23
    v_accvgpr_write_b32 a197, v24
    v_accvgpr_write_b32 a205, v25
    v_accvgpr_write_b32 a213, v26
    v_accvgpr_write_b32 a221, v27
    s_add_u32 m0, s47, 4096
    s_add_u32 s60, s49, 200704
    s_waitcnt lgkmcnt(4)
    v_mfma_f32_32x32x16_bf16 v[112:127], v[8:11], v[40:43], 0
    ds_read_b64_tr_b16 v[32:33], v5 offset:34816
    ds_read_b64_tr_b16 v[34:35], v5 offset:35328
    buffer_load_dwordx4 v3, s[16:19], s60 offen  lds
    v_accvgpr_write_b32 a229, v28
    v_accvgpr_write_b32 a237, v29
    v_accvgpr_write_b32 a245, v30
    v_accvgpr_write_b32 a253, v31
    v_cvt_pk_bf16_f32 v16, v68, v84
    v_cvt_pk_bf16_f32 v17, v69, v85
    v_cvt_pk_bf16_f32 v18, v70, v86
    v_cvt_pk_bf16_f32 v19, v71, v87
    v_mfma_f32_32x32x16_bf16 v[112:127], v[12:15], v[44:47], v[112:127]
    ds_read_b64_tr_b16 v[36:37], v5 offset:51200
    ds_read_b64_tr_b16 v[38:39], v5 offset:51712
    buffer_load_dwordx4 v3, s[16:19], s60 offen offset:2048  lds
    v_cvt_pk_bf16_f32 v20, v72, v88
    v_cvt_pk_bf16_f32 v21, v73, v89
    v_cvt_pk_bf16_f32 v22, v74, v90
    v_cvt_pk_bf16_f32 v23, v75, v91
    v_cvt_pk_bf16_f32 v226, v64, v80
    v_cvt_pk_bf16_f32 v234, v65, v81
    v_cvt_pk_bf16_f32 v242, v66, v82
    v_cvt_pk_bf16_f32 v250, v67, v83
    s_add_u32 m0, s47, 8192
    s_add_u32 s60, s49, 204800
    s_waitcnt lgkmcnt(4)
    v_mfma_f32_32x32x16_bf16 v[64:79], v[8:11], v[48:51], 0
    ds_read_b64_tr_b16 v[40:41], v5 offset:40960
    ds_read_b64_tr_b16 v[42:43], v5 offset:41472
    buffer_load_dwordx4 v2, s[16:19], s60 offen  lds
    v_cvt_pk_bf16_f32 v24, v100, v116
    v_cvt_pk_bf16_f32 v25, v101, v117
    v_cvt_pk_bf16_f32 v26, v102, v118
    v_cvt_pk_bf16_f32 v27, v103, v119
    v_cvt_pk_bf16_f32 v28, v104, v120
    v_cvt_pk_bf16_f32 v29, v105, v121
    v_cvt_pk_bf16_f32 v30, v106, v122
    v_cvt_pk_bf16_f32 v31, v107, v123
    v_mfma_f32_32x32x16_bf16 v[64:79], v[12:15], v[52:55], v[64:79]
    ds_read_b64_tr_b16 v[44:45], v5 offset:57344
    ds_read_b64_tr_b16 v[46:47], v5 offset:57856
    buffer_load_dwordx4 v2, s[16:19], s60 offen offset:2048  lds
    v_cvt_pk_bf16_f32 v230, v96, v112
    v_cvt_pk_bf16_f32 v238, v97, v113
    v_cvt_pk_bf16_f32 v246, v98, v114
    v_cvt_pk_bf16_f32 v254, v99, v115
    v_permlane32_swap_b32 v16, v24
    v_permlane32_swap_b32_e64 v17, v25
    s_add_u32 m0, s47, 12288
    s_add_u32 s60, s49, 208896
    s_waitcnt lgkmcnt(4)
    v_mfma_f32_32x32x16_bf16 v[80:95], v[8:11], v[32:35], 0
    ds_read_b64_tr_b16 v[48:49], v5 offset:43008
    ds_read_b64_tr_b16 v[50:51], v5 offset:43520
    buffer_load_dwordx4 v3, s[16:19], s60 offen  lds
    v_permlane32_swap_b32 v18, v26
    v_permlane32_swap_b32 v19, v27
    v_permlane32_swap_b32 v20, v28
    v_permlane32_swap_b32 v21, v29
    v_mfma_f32_32x32x16_bf16 v[80:95], v[12:15], v[36:39], v[80:95]
    ds_read_b64_tr_b16 v[52:53], v5 offset:59392
    ds_read_b64_tr_b16 v[54:55], v5 offset:59904
    buffer_load_dwordx4 v3, s[16:19], s60 offen offset:2048  lds
    v_permlane32_swap_b32 v22, v30
    v_permlane32_swap_b32 v23, v31
    v_permlane32_swap_b32_e64 v226, v230
    v_permlane32_swap_b32_e64 v234, v238
    s_add_u32 m0, s47, 32768
    s_add_u32 s60, s50, 196608
    buffer_load_dwordx4 v2, s[16:19], s60 offen  lds
    buffer_load_dwordx4 v2, s[16:19], s60 offen offset:2048  lds
    s_add_u32 m0, s47, 36864
    s_add_u32 s60, s50, 200704
    s_cmp_lg_u32 s40, 0
    s_cbranch_scc1 Lready
    s_mov_b32 s53, 0
    s_waitcnt vmcnt(22)
Lspin:
    v_cmp_gt_u32 vcc, 0x200000, v7
    s_add_u32 s53, s53, 1
    s_cmp_ge_u32 s53, 0x200000
    s_cbranch_scc1 Lready
    s_nop 1
    s_cbranch_vccz Lready
    buffer_load_dword v7, v57, s[28:31], 0 offen sc1
    s_waitcnt vmcnt(0)
    s_branch Lspin
Lready:
    s_waitcnt vmcnt(11) lgkmcnt(4)
    s_barrier
    v_mfma_f32_32x32x16_bf16 v[96:111], v[8:11], v[40:43], 0
    ds_read_b64_tr_b16 v[32:33], v56 offset:0
    ds_read_b64_tr_b16 v[34:35], v56 offset:512
    buffer_load_dwordx4 v3, s[16:19], s60 offen  lds
    v_accvgpr_write_b32 a194, v16
    v_accvgpr_write_b32 a202, v17
    v_accvgpr_write_b32 a210, v18
    v_accvgpr_write_b32 a218, v19
    v_accvgpr_write_b32 a226, v20
    v_accvgpr_write_b32 a234, v21
    v_permlane32_swap_b32_e64 v242, v246
    v_mfma_f32_32x32x16_bf16 v[96:111], v[12:15], v[44:47], v[96:111]
    ds_read_b64_tr_b16 v[36:37], v56 offset:16384
    ds_read_b64_tr_b16 v[38:39], v56 offset:16896
    buffer_load_dwordx4 v3, s[16:19], s60 offen offset:2048  lds
    v_permlane32_swap_b32_e64 v250, v254
    v_accvgpr_write_b32 a242, v22
    v_accvgpr_write_b32 a250, v23
    v_accvgpr_write_b32 a198, v24
    v_accvgpr_write_b32 a206, v25
    v_accvgpr_write_b32 a214, v26
    v_accvgpr_write_b32 a222, v27
    s_add_u32 m0, s47, 40960
    s_add_u32 s60, s50, 204800
    s_waitcnt lgkmcnt(4)
    v_mfma_f32_32x32x16_bf16 v[112:127], v[8:11], v[48:51], 0
    ds_read_b64_tr_b16 v[40:41], v56 offset:2048
    ds_read_b64_tr_b16 v[42:43], v56 offset:2560
    buffer_load_dwordx4 v2, s[16:19], s60 offen  lds
    v_accvgpr_write_b32 a230, v28
    v_accvgpr_write_b32 a238, v29
    v_accvgpr_write_b32 a246, v30
    v_accvgpr_write_b32 a254, v31
    v_cvt_pk_bf16_f32 v16, v68, v84
    v_cvt_pk_bf16_f32 v17, v69, v85
    v_cvt_pk_bf16_f32 v18, v70, v86
    v_cvt_pk_bf16_f32 v19, v71, v87
    v_mfma_f32_32x32x16_bf16 v[112:127], v[12:15], v[52:55], v[112:127]
    ds_read_b64_tr_b16 v[44:45], v56 offset:18432
    ds_read_b64_tr_b16 v[46:47], v56 offset:18944
    buffer_load_dwordx4 v2, s[16:19], s60 offen offset:2048  lds
    v_cvt_pk_bf16_f32 v20, v72, v88
    v_cvt_pk_bf16_f32 v21, v73, v89
    v_cvt_pk_bf16_f32 v22, v74, v90
    v_cvt_pk_bf16_f32 v23, v75, v91
    v_cvt_pk_bf16_f32 v227, v64, v80
    v_cvt_pk_bf16_f32 v235, v65, v81
    v_cvt_pk_bf16_f32 v243, v66, v82
    v_cvt_pk_bf16_f32 v251, v67, v83
    s_add_u32 m0, s47, 45056
    s_add_u32 s60, s50, 208896
    s_waitcnt lgkmcnt(4)
    v_mfma_f32_32x32x16_bf16 v[64:79], v[8:11], v[32:35], 0
    ds_read_b64_tr_b16 v[48:49], v56 offset:8192
    ds_read_b64_tr_b16 v[50:51], v56 offset:8704
    buffer_load_dwordx4 v3, s[16:19], s60 offen  lds
    v_cvt_pk_bf16_f32 v24, v100, v116
    v_cvt_pk_bf16_f32 v25, v101, v117
    v_cvt_pk_bf16_f32 v26, v102, v118
    v_cvt_pk_bf16_f32 v27, v103, v119
    v_cvt_pk_bf16_f32 v28, v104, v120
    v_cvt_pk_bf16_f32 v29, v105, v121
    v_cvt_pk_bf16_f32 v30, v106, v122
    v_cvt_pk_bf16_f32 v31, v107, v123
    v_mfma_f32_32x32x16_bf16 v[64:79], v[12:15], v[36:39], v[64:79]
    ds_read_b64_tr_b16 v[52:53], v56 offset:24576
    ds_read_b64_tr_b16 v[54:55], v56 offset:25088
    buffer_load_dwordx4 v3, s[16:19], s60 offen offset:2048  lds
    v_cvt_pk_bf16_f32 v231, v96, v112
    v_cvt_pk_bf16_f32 v239, v97, v113
    v_cvt_pk_bf16_f32 v247, v98, v114
    v_cvt_pk_bf16_f32 v255, v99, v115
    v_permlane32_swap_b32_e64 v16, v24
    v_permlane32_swap_b32 v17, v25
    s_add_u32 m0, s47, 65536
    s_add_u32 s60, s51, 196608
    s_waitcnt lgkmcnt(4)
    v_mfma_f32_32x32x16_bf16 v[80:95], v[8:11], v[40:43], 0
    ds_read_b64_tr_b16 v[32:33], v56 offset:10240
    ds_read_b64_tr_b16 v[34:35], v56 offset:10752
    buffer_load_dwordx4 v2, s[16:19], s60 offen  lds
    v_permlane32_swap_b32 v18, v26
    v_permlane32_swap_b32 v19, v27
    v_permlane32_swap_b32_e64 v20, v28
    v_permlane32_swap_b32_e64 v21, v29
    v_mfma_f32_32x32x16_bf16 v[80:95], v[12:15], v[44:47], v[80:95]
    ds_read_b64_tr_b16 v[36:37], v56 offset:26624
    ds_read_b64_tr_b16 v[38:39], v56 offset:27136
    buffer_load_dwordx4 v2, s[16:19], s60 offen offset:2048  lds
    v_permlane32_swap_b32_e64 v22, v30
    v_permlane32_swap_b32_e64 v23, v31
    v_permlane32_swap_b32_e64 v227, v231
    v_permlane32_swap_b32_e64 v235, v239
    s_add_u32 m0, s47, 69632
    s_add_u32 s60, s51, 200704
    buffer_load_dwordx4 v3, s[16:19], s60 offen  lds
    buffer_load_dwordx4 v3, s[16:19], s60 offen offset:2048  lds
    s_add_u32 m0, s47, 73728
    s_add_u32 s60, s51, 204800
    s_waitcnt vmcnt(12) lgkmcnt(4)
    s_barrier
    v_mfma_f32_32x32x16_bf16 v[96:111], v[8:11], v[48:51], 0
    ds_read_b64_tr_b16 v[40:41], v4 offset:0
    ds_read_b64_tr_b16 v[42:43], v4 offset:512
    buffer_load_dword v58, off, s[28:31], 0 offset:32 sc1
    buffer_load_dwordx4 v2, s[16:19], s60 offen  lds
    v_accvgpr_write_b32 a195, v16
    v_accvgpr_write_b32 a203, v17
    v_accvgpr_write_b32 a211, v18
    v_accvgpr_write_b32 a219, v19
    v_accvgpr_write_b32 a227, v20
    v_accvgpr_write_b32 a235, v21
    v_permlane32_swap_b32_e64 v243, v247
    v_mfma_f32_32x32x16_bf16 v[96:111], v[12:15], v[52:55], v[96:111]
    ds_read_b64_tr_b16 v[44:45], v4 offset:16384
    ds_read_b64_tr_b16 v[46:47], v4 offset:16896
    buffer_load_dwordx4 v2, s[16:19], s60 offen offset:2048  lds
    v_permlane32_swap_b32_e64 v251, v255
    v_accvgpr_write_b32 a243, v22
    v_accvgpr_write_b32 a251, v23
    v_accvgpr_write_b32 a199, v24
    v_accvgpr_write_b32 a207, v25
    v_accvgpr_write_b32 a215, v26
    v_accvgpr_write_b32 a223, v27
Lpg3:
    s_cbranch_execz Lpg7
    s_add_u32 m0, s47, 77824
    s_add_u32 s60, s51, 208896
    s_waitcnt lgkmcnt(4)
    v_mfma_f32_32x32x16_bf16 v[112:127], v[8:11], v[32:35], 0
    ds_read_b64_tr_b16 v[48:49], v4 offset:2048
    ds_read_b64_tr_b16 v[50:51], v4 offset:2560
    buffer_load_dwordx4 v3, s[16:19], s60 offen  lds
    v_accvgpr_write_b32 a231, v28
    v_accvgpr_write_b32 a239, v29
    v_accvgpr_write_b32 a247, v30
    v_accvgpr_write_b32 a255, v31
    v_cvt_pk_bf16_f32 v160, v68, v84
    v_cvt_pk_bf16_f32 v168, v69, v85
    v_cvt_pk_bf16_f32 v176, v70, v86
    v_cvt_pk_bf16_f32 v184, v71, v87
    v_mfma_f32_32x32x16_bf16 v[112:127], v[12:15], v[36:39], v[112:127]
    ds_read_b64_tr_b16 v[52:53], v4 offset:18432
    ds_read_b64_tr_b16 v[54:55], v4 offset:18944
    buffer_load_dwordx4 v3, s[16:19], s60 offen offset:2048  lds
    v_cvt_pk_bf16_f32 v192, v72, v88
    v_cvt_pk_bf16_f32 v200, v73, v89
    v_cvt_pk_bf16_f32 v208, v74, v90
    v_cvt_pk_bf16_f32 v216, v75, v91
    v_cvt_pk_bf16_f32 v128, v64, v80
    v_cvt_pk_bf16_f32 v136, v65, v81
    v_cvt_pk_bf16_f32 v144, v66, v82
    v_cvt_pk_bf16_f32 v152, v67, v83
    s_add_u32 m0, s55, 98304
    s_add_u32 s100, s54, 0
    buffer_load_dwordx4 v6, s[20:23], s100 offen offset:0 sc1 lds
    buffer_load_dwordx4 v6, s[20:23], s100 offen offset:1024 sc1 lds
    s_waitcnt lgkmcnt(4)
    v_mfma_f32_32x32x16_bf16 v[64:79], v[8:11], v[40:43], 0
    ds_read_b64_tr_b16 v[32:33], v4 offset:8192
    ds_read_b64_tr_b16 v[34:35], v4 offset:8704
    buffer_load_dwordx4 v6, s[20:23], s100 offen offset:2048 sc1 lds
    v_cvt_pk_bf16_f32 v164, v100, v116
    v_cvt_pk_bf16_f32 v172, v101, v117
    v_cvt_pk_bf16_f32 v180, v102, v118
    v_cvt_pk_bf16_f32 v188, v103, v119
    v_cvt_pk_bf16_f32 v196, v104, v120
    v_cvt_pk_bf16_f32 v204, v105, v121
    v_mfma_f32_32x32x16_bf16 v[64:79], v[12:15], v[44:47], v[64:79]
    ds_read_b64_tr_b16 v[36:37], v4 offset:24576
    ds_read_b64_tr_b16 v[38:39], v4 offset:25088
    buffer_load_dwordx4 v6, s[20:23], s100 offen offset:3072 sc1 lds
    v_cvt_pk_bf16_f32 v212, v106, v122
    v_cvt_pk_bf16_f32 v220, v107, v123
    v_cvt_pk_bf16_f32 v132, v96, v112
    v_cvt_pk_bf16_f32 v140, v97, v113
    v_cvt_pk_bf16_f32 v148, v98, v114
    v_cvt_pk_bf16_f32 v156, v99, v115
    s_add_u32 m0, s55, 102400
    s_add_u32 s100, s54, 4096
    s_waitcnt lgkmcnt(4)
    v_mfma_f32_32x32x16_bf16 v[80:95], v[8:11], v[48:51], 0
    ds_read_b64_tr_b16 v[40:41], v4 offset:10240
    ds_read_b64_tr_b16 v[42:43], v4 offset:10752
    ds_read_b64_tr_b16 v[44:45], v4 offset:26624
    ds_read_b64_tr_b16 v[46:47], v4 offset:27136
    buffer_load_dwordx4 v6, s[20:23], s100 offen offset:0 sc1 lds
    v_permlane32_swap_b32 v160, v164
    v_permlane32_swap_b32 v168, v172
    v_permlane32_swap_b32 v176, v180
    v_mfma_f32_32x32x16_bf16 v[80:95], v[12:15], v[52:55], v[80:95]
    buffer_load_dwordx4 v6, s[20:23], s100 offen offset:1024 sc1 lds
    v_permlane32_swap_b32 v184, v188
    v_permlane32_swap_b32 v192, v196
    v_permlane32_swap_b32_e64 v200, v204
    buffer_load_dwordx4 v6, s[20:23], s100 offen offset:2048 sc1 lds
    buffer_load_dwordx4 v6, s[20:23], s100 offen offset:3072 sc1 lds
    s_add_u32 m0, s55, 131072
    s_add_u32 s100, s54, 32768
    s_waitcnt vmcnt(8) lgkmcnt(0)
    s_barrier
    v_mfma_f32_32x32x16_bf16 v[96:111], v[8:11], v[32:35], 0
    ds_read_b64_tr_b16 v[48:49], v4 offset:32768
    ds_read_b64_tr_b16 v[50:51], v4 offset:33280
    buffer_load_dwordx4 v6, s[20:23], s100 offen offset:0 sc1 lds
    v_permlane32_swap_b32 v208, v212
    v_permlane32_swap_b32 v216, v220
    v_permlane32_swap_b32_e64 v128, v132
    v_mfma_f32_32x32x16_bf16 v[96:111], v[12:15], v[36:39], v[96:111]
    ds_read_b64_tr_b16 v[52:53], v4 offset:49152
    ds_read_b64_tr_b16 v[54:55], v4 offset:49664
    buffer_load_dwordx4 v6, s[20:23], s100 offen offset:1024 sc1 lds
    v_permlane32_swap_b32 v136, v140
    v_permlane32_swap_b32 v144, v148
    v_permlane32_swap_b32 v152, v156
    s_waitcnt lgkmcnt(4)
    v_mfma_f32_32x32x16_bf16 v[112:127], v[8:11], v[40:43], 0
    ds_read_b64_tr_b16 v[32:33], v4 offset:34816
    ds_read_b64_tr_b16 v[34:35], v4 offset:35328
    buffer_load_dwordx4 v6, s[20:23], s100 offen offset:2048 sc1 lds
    v_cvt_pk_bf16_f32 v161, v68, v84
    v_cvt_pk_bf16_f32 v169, v69, v85
    v_cvt_pk_bf16_f32 v177, v70, v86
    v_cvt_pk_bf16_f32 v185, v71, v87
    v_cvt_pk_bf16_f32 v193, v72, v88
    v_cvt_pk_bf16_f32 v201, v73, v89
    v_mfma_f32_32x32x16_bf16 v[112:127], v[12:15], v[44:47], v[112:127]
    ds_read_b64_tr_b16 v[36:37], v4 offset:51200
    ds_read_b64_tr_b16 v[38:39], v4 offset:51712
    buffer_load_dwordx4 v6, s[20:23], s100 offen offset:3072 sc1 lds
    v_cvt_pk_bf16_f32 v209, v74, v90
    v_cvt_pk_bf16_f32 v217, v75, v91
    v_cvt_pk_bf16_f32 v129, v64, v80
    v_cvt_pk_bf16_f32 v137, v65, v81
    v_cvt_pk_bf16_f32 v145, v66, v82
    v_cvt_pk_bf16_f32 v153, v67, v83
    s_add_u32 m0, s55, 135168
    s_add_u32 s100, s54, 36864
    s_waitcnt lgkmcnt(4)
    v_mfma_f32_32x32x16_bf16 v[64:79], v[8:11], v[48:51], 0
    ds_read_b64_tr_b16 v[40:41], v4 offset:40960
    ds_read_b64_tr_b16 v[42:43], v4 offset:41472
    buffer_load_dwordx4 v6, s[20:23], s100 offen offset:0 sc1 lds
    v_cvt_pk_bf16_f32 v165, v100, v116
    v_cvt_pk_bf16_f32 v173, v101, v117
    v_cvt_pk_bf16_f32 v181, v102, v118
    v_cvt_pk_bf16_f32 v189, v103, v119
    v_cvt_pk_bf16_f32 v197, v104, v120
    v_cvt_pk_bf16_f32 v205, v105, v121
    v_mfma_f32_32x32x16_bf16 v[64:79], v[12:15], v[52:55], v[64:79]
    ds_read_b64_tr_b16 v[44:45], v4 offset:57344
    ds_read_b64_tr_b16 v[46:47], v4 offset:57856
    buffer_load_dwordx4 v6, s[20:23], s100 offen offset:1024 sc1 lds
    v_cvt_pk_bf16_f32 v213, v106, v122
    v_cvt_pk_bf16_f32 v221, v107, v123
    v_cvt_pk_bf16_f32 v133, v96, v112
    v_cvt_pk_bf16_f32 v141, v97, v113
    v_cvt_pk_bf16_f32 v149, v98, v114
    v_cvt_pk_bf16_f32 v157, v99, v115
    s_waitcnt lgkmcnt(4)
    v_mfma_f32_32x32x16_bf16 v[80:95], v[8:11], v[32:35], 0
    ds_read_b64_tr_b16 v[48:49], v4 offset:43008
    ds_read_b64_tr_b16 v[50:51], v4 offset:43520
    buffer_load_dwordx4 v6, s[20:23], s100 offen offset:2048 sc1 lds
    v_permlane32_swap_b32 v161, v165
    v_permlane32_swap_b32 v169, v173
    v_permlane32_swap_b32_e64 v177, v181
    v_mfma_f32_32x32x16_bf16 v[80:95], v[12:15], v[36:39], v[80:95]
    ds_read_b64_tr_b16 v[52:53], v4 offset:59392
    ds_read_b64_tr_b16 v[54:55], v4 offset:59904
    buffer_load_dwordx4 v6, s[20:23], s100 offen offset:3072 sc1 lds
    v_permlane32_swap_b32 v185, v189
    v_permlane32_swap_b32 v193, v197
    v_permlane32_swap_b32_e64 v201, v205
    s_add_u32 m0, s55, 0
    s_add_u32 s100, s54, 65536
    s_waitcnt lgkmcnt(4)
    v_mfma_f32_32x32x16_bf16 v[96:111], v[8:11], v[40:43], 0
    ds_read_b64_tr_b16 v[32:33], v5 offset:0
    ds_read_b64_tr_b16 v[34:35], v5 offset:512
    buffer_load_dwordx4 v6, s[20:23], s100 offen offset:0 sc1 lds
    v_permlane32_swap_b32 v209, v213
    v_permlane32_swap_b32 v217, v221
    v_permlane32_swap_b32_e64 v129, v133
    v_mfma_f32_32x32x16_bf16 v[96:111], v[12:15], v[44:47], v[96:111]
    ds_read_b64_tr_b16 v[36:37], v5 offset:16384
    ds_read_b64_tr_b16 v[38:39], v5 offset:16896
    buffer_load_dwordx4 v6, s[20:23], s100 offen offset:1024 sc1 lds
    v_permlane32_swap_b32 v137, v141
    v_permlane32_swap_b32 v145, v149
    v_permlane32_swap_b32 v153, v157
    s_waitcnt lgkmcnt(4)
    v_mfma_f32_32x32x16_bf16 v[112:127], v[8:11], v[48:51], 0
    ds_read_b64_tr_b16 v[40:41], v5 offset:2048
    ds_read_b64_tr_b16 v[42:43], v5 offset:2560
    buffer_load_dwordx4 v6, s[20:23], s100 offen offset:2048 sc1 lds
    v_cvt_pk_bf16_f32 v162, v68, v84
    v_cvt_pk_bf16_f32 v170, v69, v85
    v_cvt_pk_bf16_f32 v178, v70, v86
    v_cvt_pk_bf16_f32 v186, v71, v87
    v_cvt_pk_bf16_f32 v194, v72, v88
    v_cvt_pk_bf16_f32 v202, v73, v89
    v_mfma_f32_32x32x16_bf16 v[112:127], v[12:15], v[52:55], v[112:127]
    ds_read_b64_tr_b16 v[44:45], v5 offset:18432
    ds_read_b64_tr_b16 v[46:47], v5 offset:18944
    buffer_load_dwordx4 v6, s[20:23], s100 offen offset:3072 sc1 lds
    v_cvt_pk_bf16_f32 v210, v74, v90
    v_cvt_pk_bf16_f32 v218, v75, v91
    v_cvt_pk_bf16_f32 v130, v64, v80
    v_cvt_pk_bf16_f32 v138, v65, v81
    v_cvt_pk_bf16_f32 v146, v66, v82
    v_cvt_pk_bf16_f32 v154, v67, v83
    s_add_u32 m0, s55, 4096
    s_add_u32 s100, s54, 69632
    s_waitcnt lgkmcnt(4)
    v_mfma_f32_32x32x16_bf16 v[64:79], v[8:11], v[32:35], 0
    ds_read_b64_tr_b16 v[48:49], v5 offset:8192
    ds_read_b64_tr_b16 v[50:51], v5 offset:8704
    buffer_load_dwordx4 v6, s[20:23], s100 offen offset:0 sc1 lds
    v_cvt_pk_bf16_f32 v166, v100, v116
    v_cvt_pk_bf16_f32 v174, v101, v117
    v_cvt_pk_bf16_f32 v182, v102, v118
    v_cvt_pk_bf16_f32 v190, v103, v119
    v_cvt_pk_bf16_f32 v198, v104, v120
    v_cvt_pk_bf16_f32 v206, v105, v121
    v_mfma_f32_32x32x16_bf16 v[64:79], v[12:15], v[36:39], v[64:79]
    ds_read_b64_tr_b16 v[52:53], v5 offset:24576
    ds_read_b64_tr_b16 v[54:55], v5 offset:25088
    buffer_load_dwordx4 v6, s[20:23], s100 offen offset:1024 sc1 lds
    v_cvt_pk_bf16_f32 v214, v106, v122
    v_cvt_pk_bf16_f32 v222, v107, v123
    v_cvt_pk_bf16_f32 v134, v96, v112
    v_cvt_pk_bf16_f32 v142, v97, v113
    v_cvt_pk_bf16_f32 v150, v98, v114
    v_cvt_pk_bf16_f32 v158, v99, v115
    s_waitcnt lgkmcnt(4)
    v_mfma_f32_32x32x16_bf16 v[80:95], v[8:11], v[40:43], 0
    ds_read_b64_tr_b16 v[32:33], v5 offset:10240
    ds_read_b64_tr_b16 v[34:35], v5 offset:10752
    ds_read_b64_tr_b16 v[36:37], v5 offset:26624
    ds_read_b64_tr_b16 v[38:39], v5 offset:27136
    buffer_load_dwordx4 v6, s[20:23], s100 offen offset:2048 sc1 lds
    v_permlane32_swap_b32 v162, v166
    v_permlane32_swap_b32 v170, v174
    v_permlane32_swap_b32_e64 v178, v182
    v_mfma_f32_32x32x16_bf16 v[80:95], v[12:15], v[44:47], v[80:95]
    buffer_load_dwordx4 v6, s[20:23], s100 offen offset:3072 sc1 lds
    v_permlane32_swap_b32_e64 v186, v190
    v_permlane32_swap_b32 v194, v198
    v_permlane32_swap_b32 v202, v206
    s_waitcnt lgkmcnt(4)
    v_mfma_f32_32x32x16_bf16 v[96:111], v[8:11], v[48:51], 0
    v_permlane32_swap_b32 v210, v214
    v_permlane32_swap_b32 v218, v222
    v_permlane32_swap_b32 v130, v134
    v_mfma_f32_32x32x16_bf16 v[96:111], v[12:15], v[52:55], v[96:111]
    v_permlane32_swap_b32 v138, v142
    v_permlane32_swap_b32 v146, v150
    v_permlane32_swap_b32 v154, v158
    s_waitcnt lgkmcnt(0)
    v_mfma_f32_32x32x16_bf16 v[112:127], v[8:11], v[32:35], 0
    v_cvt_pk_bf16_f32 v163, v68, v84
    v_cvt_pk_bf16_f32 v171, v69, v85
    v_cvt_pk_bf16_f32 v179, v70, v86
    v_cvt_pk_bf16_f32 v187, v71, v87
    v_cvt_pk_bf16_f32 v195, v72, v88
    v_cvt_pk_bf16_f32 v203, v73, v89
    v_mfma_f32_32x32x16_bf16 v[112:127], v[12:15], v[36:39], v[112:127]
    v_cvt_pk_bf16_f32 v211, v74, v90
    v_cvt_pk_bf16_f32 v219, v75, v91
    v_cvt_pk_bf16_f32 v131, v64, v80
    v_cvt_pk_bf16_f32 v139, v65, v81
    v_cvt_pk_bf16_f32 v147, v66, v82
    v_cvt_pk_bf16_f32 v155, v67, v83
Lb:
    v_mov_b32 v8, v59
    v_xor_b32 v9, 16, v59
    v_xor_b32 v10, 32, v59
    v_xor_b32 v11, 48, v59
    v_xor_b32 v12, 64, v59
    v_xor_b32 v13, 80, v59
    v_xor_b32 v14, 96, v59
    v_xor_b32 v15, 112, v59
    s_waitcnt vmcnt(16)
    s_barrier
    v_readfirstlane_b32 s52, v58
    ds_read_b128 v[32:35], v8 offset:0
    ds_read_b128 v[36:39], v9 offset:0
    ds_read_b128 v[40:43], v8 offset:8192
    ds_read_b128 v[44:47], v9 offset:8192
    ds_read_b128 v[48:51], v8 offset:16384
    ds_read_b128 v[52:55], v9 offset:16384
    v_cvt_pk_bf16_f32 v135, v96, v112
    v_cvt_pk_bf16_f32 v143, v97, v113
    v_cvt_pk_bf16_f32 v151, v98, v114
    v_cvt_pk_bf16_f32 v159, v99, v115
    s_nop 1
    v_permlane32_swap_b32 v131, v135
    v_permlane32_swap_b32 v139, v143
    v_permlane32_swap_b32 v147, v151
    v_permlane32_swap_b32 v155, v159
    s_bfe_u32 s53, s52, 0x80008
    s_and_b32 s52, s52, 255
    s_sub_u32 s52, s53, s52
    s_cmp_ge_i32 s52, 8
    s_cselect_b32 s95, 0x2000, 0
    s_abs_i32 s52, s52
    s_cmp_lt_u32 s52, 8
    s_cselect_b32 s94, 0x2000, 0
    s_lshl_b32 s53, s46, 13
    s_and_b32 s53, s53, s94
    s_or_b32 s53, s53, s95
    s_xor_b32 s56, s56, s53
    s_xor_b32 s3, s3, s53
    s_mov_b32 s92, s53
    s_lshr_b32 s59, s45, 1
    s_add_u32 m0, s55, 32768
    s_waitcnt lgkmcnt(4)
    v_mfma_f32_16x16x32_bf16 v[64:67], v[32:35], a[0:3], 0
    ds_read_b128 v[56:59], v8 offset:24576
    ds_read_b128 v[60:63], v9 offset:24576
    v_cvt_pk_bf16_f32 v167, v100, v116
    v_mfma_f32_16x16x32_bf16 v[72:75], v[32:35], a[4:7], 0
    s_add_u32 s100, s54, 98304
    buffer_load_dwordx4 v6, s[20:23], s100 offen offset:0 sc1 lds
    v_mfma_f32_16x16x32_bf16 v[68:71], v[36:39], a[4:7], 0
    v_cvt_pk_bf16_f32 v175, v101, v117
    v_cvt_pk_bf16_f32 v183, v102, v118
    v_mfma_f32_16x16x32_bf16 v[72:75], v[36:39], a[0:3], v[72:75]
    s_waitcnt lgkmcnt(4)
    v_cvt_pk_bf16_f32 v191, v103, v119
    v_cvt_pk_bf16_f32 v199, v104, v120
    v_mfma_f32_16x16x32_bf16 v[64:67], v[40:43], a[96:99], v[64:67]
    ds_read_b128 v[32:35], v10 offset:0
    ds_read_b128 v[36:39], v11 offset:0
    v_cvt_pk_bf16_f32 v207, v105, v121
    v_mfma_f32_16x16x32_bf16 v[72:75], v[40:43], a[100:103], v[72:75]
    buffer_load_dwordx4 v6, s[20:23], s100 offen offset:1024 sc1 lds
    v_mfma_f32_16x16x32_bf16 v[68:71], v[44:47], a[100:103], v[68:71]
    v_cvt_pk_bf16_f32 v215, v106, v122
    v_cvt_pk_bf16_f32 v223, v107, v123
    v_mfma_f32_16x16x32_bf16 v[72:75], v[44:47], a[96:99], v[72:75]
    s_waitcnt lgkmcnt(4)
    v_permlane32_swap_b32 v163, v167
    v_permlane32_swap_b32_e64 v171, v175
    v_mfma_f32_16x16x32_bf16 v[64:67], v[48:51], v[224:227], v[64:67]
    ds_read_b128 v[40:43], v10 offset:8192
    ds_read_b128 v[44:47], v11 offset:8192
    v_permlane32_swap_b32_e64 v179, v183
    v_mfma_f32_16x16x32_bf16 v[72:75], v[48:51], v[228:231], v[72:75]
    buffer_load_dwordx4 v6, s[20:23], s100 offen offset:2048 sc1 lds
    v_mfma_f32_16x16x32_bf16 v[68:71], v[52:55], v[228:231], v[68:71]
    v_permlane32_swap_b32 v187, v191
    v_permlane32_swap_b32 v195, v199
    v_mfma_f32_16x16x32_bf16 v[72:75], v[52:55], v[224:227], v[72:75]
    s_waitcnt lgkmcnt(4)
    v_permlane32_swap_b32 v203, v207
    v_permlane32_swap_b32 v211, v215
    v_mfma_f32_16x16x32_bf16 v[64:67], v[56:59], v[128:131], v[64:67]
    ds_read_b128 v[48:51], v10 offset:16384
    ds_read_b128 v[52:55], v11 offset:16384
    v_permlane32_swap_b32 v219, v223
    v_mfma_f32_16x16x32_bf16 v[72:75], v[56:59], v[132:135], v[72:75]
    buffer_load_dwordx4 v6, s[20:23], s100 offen offset:3072 sc1 lds
    v_mfma_f32_16x16x32_bf16 v[68:71], v[60:63], v[132:135], v[68:71]
    s_add_u32 m0, s55, 36864
    v_lshrrev_b32 v4, 4, v1
    v_and_b32_e64 v5, 15, v1
    v_mfma_f32_16x16x32_bf16 v[72:75], v[60:63], v[128:131], v[72:75]
    s_waitcnt lgkmcnt(4)
    v_lshlrev_b32_e64 v7, 2, v4
    v_xor_b32_e64 v7, v5, v7
    v_mfma_f32_16x16x32_bf16 v[76:79], v[32:35], a[8:11], 0
    ds_read_b128 v[56:59], v10 offset:24576
    ds_read_b128 v[60:63], v11 offset:24576
    v_lshlrev_b32_e64 v3, 10, v4
    v_mfma_f32_16x16x32_bf16 v[84:87], v[32:35], a[12:15], 0
    s_add_u32 s100, s54, 102400
    buffer_load_dwordx4 v6, s[20:23], s100 offen offset:0 sc1 lds
    v_mfma_f32_16x16x32_bf16 v[80:83], v[36:39], a[12:15], 0
    v_lshl_add_u32 v3, v7, 4, v3
    v_lshlrev_b32 v2, 22, v4
    v_mfma_f32_16x16x32_bf16 v[84:87], v[36:39], a[8:11], v[84:87]
    s_waitcnt lgkmcnt(4)
    v_and_b32_e64 v5, 7, v1
    v_lshl_add_u32 v2, v5, 4, v2
    v_mfma_f32_16x16x32_bf16 v[76:79], v[40:43], a[104:107], v[76:79]
    ds_read_b128 v[32:35], v12 offset:0
    ds_read_b128 v[36:39], v13 offset:0
    v_mfma_f32_16x16x32_bf16 v[84:87], v[40:43], a[108:111], v[84:87]
    buffer_load_dwordx4 v6, s[20:23], s100 offen offset:1024 sc1 lds
    v_mfma_f32_16x16x32_bf16 v[80:83], v[44:47], a[108:111], v[80:83]
    v_bfe_u32 v5, v1, 3, 1
    v_xor_b32 v5, s59, v5
    v_mfma_f32_16x16x32_bf16 v[84:87], v[44:47], a[104:107], v[84:87]
    s_waitcnt lgkmcnt(4)
    v_lshl_add_u32 v2, v5, 15, v2
    v_lshlrev_b32_e64 v5, 31, v5
    v_mfma_f32_16x16x32_bf16 v[76:79], v[48:51], v[232:235], v[76:79]
    ds_read_b128 v[40:43], v12 offset:8192
    ds_read_b128 v[44:47], v13 offset:8192
    v_mfma_f32_16x16x32_bf16 v[84:87], v[48:51], v[236:239], v[84:87]
    buffer_load_dwordx4 v6, s[20:23], s100 offen offset:2048 sc1 lds
    v_mfma_f32_16x16x32_bf16 v[80:83], v[52:55], v[236:239], v[80:83]
    v_or_b32_e64 v4, 1.0, v5
    v_lshlrev_b32 v5, 9, v1
    v_mfma_f32_16x16x32_bf16 v[84:87], v[52:55], v[232:235], v[84:87]
    s_waitcnt lgkmcnt(4)
    v_and_b32 v7, 0x800, v5
    v_mad_u32_u24 v5, v7, 3, v5
    v_mfma_f32_16x16x32_bf16 v[76:79], v[56:59], v[136:139], v[76:79]
    ds_read_b128 v[48:51], v12 offset:16384
    ds_read_b128 v[52:55], v13 offset:16384
    v_mfma_f32_16x16x32_bf16 v[84:87], v[56:59], v[140:143], v[84:87]
    buffer_load_dwordx4 v6, s[20:23], s100 offen offset:3072 sc1 lds
    v_mfma_f32_16x16x32_bf16 v[80:83], v[60:63], v[140:143], v[80:83]
    s_add_u32 m0, s55, 65536
    s_add_u32 s52, s45, 0
    s_and_b32 s52, s52, 3
    s_lshl_b32 s52, s52, 17
    s_add_u32 s48, s64, s52
    s_add_u32 s52, s45, 1
    s_and_b32 s52, s52, 3
    s_lshl_b32 s52, s52, 17
    s_add_u32 s49, s64, s52
    v_mfma_f32_16x16x32_bf16 v[84:87], v[60:63], v[136:139], v[84:87]
    s_waitcnt lgkmcnt(4)
    s_add_u32 s52, s45, 2
    s_and_b32 s52, s52, 3
    s_lshl_b32 s52, s52, 17
    s_add_u32 s50, s64, s52
    s_add_u32 s52, s45, 3
    s_and_b32 s52, s52, 3
    s_lshl_b32 s52, s52, 17
    s_add_u32 s51, s64, s52
    v_mfma_f32_16x16x32_bf16 v[88:91], v[32:35], a[16:19], 0
    ds_read_b128 v[56:59], v12 offset:24576
    ds_read_b128 v[60:63], v13 offset:24576
    v_mfma_f32_16x16x32_bf16 v[96:99], v[32:35], a[20:23], 0
    s_add_u32 s100, s54, 131072
    buffer_load_dwordx4 v6, s[20:23], s100 offen offset:0 sc1 lds
    v_mfma_f32_16x16x32_bf16 v[92:95], v[36:39], a[20:23], 0
    v_sub_f32 v64, v64, v68
    v_sub_f32 v76, v76, v80
    v_mfma_f32_16x16x32_bf16 v[96:99], v[36:39], a[16:19], v[96:99]
    s_waitcnt lgkmcnt(4)
    v_fma_f32 v80, -v76, v4, v64
    v_fma_f32 v68, -v84, v4, v72
    v_mfma_f32_16x16x32_bf16 v[88:91], v[40:43], a[112:115], v[88:91]
    ds_read_b128 v[32:35], v14 offset:0
    ds_read_b128 v[36:39], v15 offset:0
    v_fmac_f32_e64 v64, v76, v4
    v_mfma_f32_16x16x32_bf16 v[96:99], v[40:43], a[116:119], v[96:99]
    buffer_load_dwordx4 v6, s[20:23], s100 offen offset:1024 sc1 lds
    v_mfma_f32_16x16x32_bf16 v[92:95], v[44:47], a[116:119], v[92:95]
    v_cvt_pk_bf16_f32 v80, v80, v68
    v_fmac_f32 v72, v84, v4
    v_mfma_f32_16x16x32_bf16 v[96:99], v[44:47], a[112:115], v[96:99]
    s_waitcnt lgkmcnt(4)
    v_cvt_pk_bf16_f32 v112, v64, v72
    v_mov_b32_dpp v114, v80 row_ror:8 row_mask:0xf bank_mask:0xf
    v_mfma_f32_16x16x32_bf16 v[88:91], v[48:51], v[240:243], v[88:91]
    ds_read_b128 v[40:43], v14 offset:8192
    ds_read_b128 v[44:47], v15 offset:8192
    v_sub_f32_e64 v65, v65, v69
    v_mfma_f32_16x16x32_bf16 v[96:99], v[48:51], v[244:247], v[96:99]
    buffer_load_dwordx4 v6, s[20:23], s100 offen offset:2048 sc1 lds
    v_mfma_f32_16x16x32_bf16 v[92:95], v[52:55], v[244:247], v[92:95]
    v_sub_f32_e64 v77, v77, v81
    v_fma_f32 v81, -v77, v4, v65
    v_mfma_f32_16x16x32_bf16 v[96:99], v[52:55], v[240:243], v[96:99]
    s_waitcnt lgkmcnt(4)
    v_fma_f32 v69, -v85, v4, v73
    v_fmac_f32 v65, v77, v4
    v_mfma_f32_16x16x32_bf16 v[88:91], v[56:59], v[144:147], v[88:91]
    ds_read_b128 v[48:51], v14 offset:16384
    ds_read_b128 v[52:55], v15 offset:16384
    v_cvt_pk_bf16_f32 v81, v81, v69
    v_mfma_f32_16x16x32_bf16 v[96:99], v[56:59], v[148:151], v[96:99]
    buffer_load_dwordx4 v6, s[20:23], s100 offen offset:3072 sc1 lds
    v_mfma_f32_16x16x32_bf16 v[92:95], v[60:63], v[148:151], v[92:95]
    s_add_u32 m0, s55, 69632
    v_fmac_f32 v73, v85, v4
    v_cvt_pk_bf16_f32 v116, v65, v73
    v_mfma_f32_16x16x32_bf16 v[96:99], v[60:63], v[144:147], v[96:99]
    s_waitcnt lgkmcnt(4)
    v_mov_b32_dpp v118, v81 row_ror:8 row_mask:0xf bank_mask:0xf
    v_sub_f32_e64 v66, v66, v70
    v_mfma_f32_16x16x32_bf16 v[100:103], v[32:35], a[24:27], 0
    ds_read_b128 v[56:59], v14 offset:24576
    ds_read_b128 v[60:63], v15 offset:24576
    v_sub_f32_e64 v78, v78, v82
    v_mfma_f32_16x16x32_bf16 v[108:111], v[32:35], a[28:31], 0
    s_add_u32 s100, s54, 135168
    buffer_load_dwordx4 v6, s[20:23], s100 offen offset:0 sc1 lds
    v_mfma_f32_16x16x32_bf16 v[104:107], v[36:39], a[28:31], 0
    v_fma_f32 v82, -v78, v4, v66
    v_fma_f32 v70, -v86, v4, v74
    v_mfma_f32_16x16x32_bf16 v[108:111], v[36:39], a[24:27], v[108:111]
    s_waitcnt lgkmcnt(4)
    v_fmac_f32 v66, v78, v4
    v_cvt_pk_bf16_f32 v82, v82, v70
    v_mfma_f32_16x16x32_bf16 v[100:103], v[40:43], a[120:123], v[100:103]
    s_waitcnt vmcnt(21)
    s_barrier
    ds_read_b128 v[32:35], v8 offset:32768
    ds_read_b128 v[36:39], v9 offset:32768
    v_mfma_f32_16x16x32_bf16 v[108:111], v[40:43], a[124:127], v[108:111]
    buffer_load_dwordx4 v6, s[20:23], s100 offen offset:1024 sc1 lds
    v_mfma_f32_16x16x32_bf16 v[104:107], v[44:47], a[124:127], v[104:107]
    v_fmac_f32 v74, v86, v4
    v_cvt_pk_bf16_f32 v120, v66, v74
    v_mfma_f32_16x16x32_bf16 v[108:111], v[44:47], a[120:123], v[108:111]
    s_waitcnt lgkmcnt(4)
    v_mov_b32_dpp v122, v82 row_ror:8 row_mask:0xf bank_mask:0xf
    v_sub_f32_e64 v67, v67, v71
    v_mfma_f32_16x16x32_bf16 v[100:103], v[48:51], v[248:251], v[100:103]
    ds_read_b128 v[40:43], v8 offset:40960
    ds_read_b128 v[44:47], v9 offset:40960
    v_mfma_f32_16x16x32_bf16 v[108:111], v[48:51], v[252:255], v[108:111]
    buffer_load_dwordx4 v6, s[20:23], s100 offen offset:2048 sc1 lds
    v_mfma_f32_16x16x32_bf16 v[104:107], v[52:55], v[252:255], v[104:107]
    v_sub_f32 v79, v79, v83
    v_fma_f32 v83, -v79, v4, v67
    v_mfma_f32_16x16x32_bf16 v[108:111], v[52:55], v[248:251], v[108:111]
    s_waitcnt lgkmcnt(4)
    v_fma_f32 v71, -v87, v4, v75
    v_fmac_f32_e64 v67, v79, v4
    v_mfma_f32_16x16x32_bf16 v[100:103], v[56:59], v[152:155], v[100:103]
    ds_read_b128 v[48:51], v8 offset:49152
    ds_read_b128 v[52:55], v9 offset:49152
    v_mfma_f32_16x16x32_bf16 v[108:111], v[56:59], v[156:159], v[108:111]
    buffer_load_dwordx4 v6, s[20:23], s100 offen offset:3072 sc1 lds
    v_mfma_f32_16x16x32_bf16 v[104:107], v[60:63], v[156:159], v[104:107]
    v_cvt_pk_bf16_f32 v83, v83, v71
    v_fmac_f32 v75, v87, v4
    v_mfma_f32_16x16x32_bf16 v[108:111], v[60:63], v[152:155], v[108:111]
    s_waitcnt lgkmcnt(4)
    v_cvt_pk_bf16_f32 v124, v67, v75
    v_mov_b32_dpp v126, v83 row_ror:8 row_mask:0xf bank_mask:0xf
    v_mfma_f32_16x16x32_bf16 v[64:67], v[32:35], a[0:3], 0
    ds_read_b128 v[56:59], v8 offset:57344
    ds_read_b128 v[60:63], v9 offset:57344
    v_mfma_f32_16x16x32_bf16 v[72:75], v[32:35], a[4:7], 0
    v_mfma_f32_16x16x32_bf16 v[68:71], v[36:39], a[4:7], 0
    v_sub_f32 v88, v88, v92
    v_sub_f32_e64 v100, v100, v104
    v_mfma_f32_16x16x32_bf16 v[72:75], v[36:39], a[0:3], v[72:75]
    s_waitcnt lgkmcnt(4)
    v_fma_f32 v104, -v100, v4, v88
    v_fma_f32 v92, -v108, v4, v96
    v_mfma_f32_16x16x32_bf16 v[64:67], v[40:43], a[96:99], v[64:67]
    ds_read_b128 v[32:35], v10 offset:32768
    ds_read_b128 v[36:39], v11 offset:32768
    v_mfma_f32_16x16x32_bf16 v[72:75], v[40:43], a[100:103], v[72:75]
    v_fmac_f32_e64 v88, v100, v4
    v_cvt_pk_bf16_f32 v104, v104, v92
    v_mfma_f32_16x16x32_bf16 v[68:71], v[44:47], a[100:103], v[68:71]
    v_fmac_f32 v96, v108, v4
    v_cvt_pk_bf16_f32 v113, v88, v96
    v_mfma_f32_16x16x32_bf16 v[72:75], v[44:47], a[96:99], v[72:75]
    s_waitcnt lgkmcnt(4)
    v_mov_b32_dpp v115, v104 row_ror:8 row_mask:0xf bank_mask:0xf
    v_sub_f32_e64 v89, v89, v93
    v_mfma_f32_16x16x32_bf16 v[64:67], v[48:51], v[224:227], v[64:67]
    ds_read_b128 v[40:43], v10 offset:40960
    ds_read_b128 v[44:47], v11 offset:40960
    v_mfma_f32_16x16x32_bf16 v[72:75], v[48:51], v[228:231], v[72:75]
    v_sub_f32_e64 v101, v101, v105
    v_fma_f32 v105, -v101, v4, v89
    v_mfma_f32_16x16x32_bf16 v[68:71], v[52:55], v[228:231], v[68:71]
    v_fma_f32 v93, -v109, v4, v97
    v_fmac_f32 v89, v101, v4
    v_mfma_f32_16x16x32_bf16 v[72:75], v[52:55], v[224:227], v[72:75]
    s_waitcnt lgkmcnt(4)
    v_cvt_pk_bf16_f32 v105, v105, v93
    v_fmac_f32_e64 v97, v109, v4
    v_mfma_f32_16x16x32_bf16 v[64:67], v[56:59], v[128:131], v[64:67]
    ds_read_b128 v[48:51], v10 offset:49152
    ds_read_b128 v[52:55], v11 offset:49152
    v_mfma_f32_16x16x32_bf16 v[72:75], v[56:59], v[132:135], v[72:75]
    s_xor_b32 s101, s56, 33554432
    buffer_store_dwordx4 v[112:115], v2, s[20:23], s101 offen sc0 sc1
    v_mfma_f32_16x16x32_bf16 v[68:71], v[60:63], v[132:135], v[68:71]
    v_cvt_pk_bf16_f32 v117, v89, v97
    v_mov_b32_dpp v119, v105 row_ror:8 row_mask:0xf bank_mask:0xf
    v_mfma_f32_16x16x32_bf16 v[72:75], v[60:63], v[128:131], v[72:75]
    s_waitcnt lgkmcnt(4)
    v_sub_f32 v90, v90, v94
    v_sub_f32_e64 v102, v102, v106
    v_mfma_f32_16x16x32_bf16 v[76:79], v[32:35], a[8:11], 0
    ds_read_b128 v[56:59], v10 offset:57344
    ds_read_b128 v[60:63], v11 offset:57344
    v_mfma_f32_16x16x32_bf16 v[84:87], v[32:35], a[12:15], 0
    v_fma_f32 v106, -v102, v4, v90
    v_mfma_f32_16x16x32_bf16 v[80:83], v[36:39], a[12:15], 0
    v_fma_f32 v94, -v110, v4, v98
    v_fmac_f32 v90, v102, v4
    v_mfma_f32_16x16x32_bf16 v[84:87], v[36:39], a[8:11], v[84:87]
    s_waitcnt lgkmcnt(4)
    v_cvt_pk_bf16_f32 v106, v106, v94
    v_fmac_f32_e64 v98, v110, v4
    v_mfma_f32_16x16x32_bf16 v[76:79], v[40:43], a[104:107], v[76:79]
    ds_read_b128 v[32:35], v12 offset:32768
    ds_read_b128 v[36:39], v13 offset:32768
Lpg4:
    s_cbranch_execz Lpg8
    v_mfma_f32_16x16x32_bf16 v[84:87], v[40:43], a[108:111], v[84:87]
    s_xor_b32 s101, s56, 33558528
    buffer_store_dwordx4 v[116:119], v2, s[20:23], s101 offen sc0 sc1
    v_mfma_f32_16x16x32_bf16 v[80:83], v[44:47], a[108:111], v[80:83]
    v_cvt_pk_bf16_f32 v121, v90, v98
    v_mov_b32_dpp v123, v106 row_ror:8 row_mask:0xf bank_mask:0xf
    v_mfma_f32_16x16x32_bf16 v[84:87], v[44:47], a[104:107], v[84:87]
    s_waitcnt lgkmcnt(4)
    v_sub_f32 v91, v91, v95
    v_sub_f32 v103, v103, v107
    v_mfma_f32_16x16x32_bf16 v[76:79], v[48:51], v[232:235], v[76:79]
    ds_read_b128 v[40:43], v12 offset:40960
    ds_read_b128 v[44:47], v13 offset:40960
    v_mfma_f32_16x16x32_bf16 v[84:87], v[48:51], v[236:239], v[84:87]
    v_fma_f32 v107, -v103, v4, v91
    v_mfma_f32_16x16x32_bf16 v[80:83], v[52:55], v[236:239], v[80:83]
    v_fma_f32 v95, -v111, v4, v99
    v_fmac_f32 v91, v103, v4
    v_mfma_f32_16x16x32_bf16 v[84:87], v[52:55], v[232:235], v[84:87]
    s_waitcnt lgkmcnt(4)
    v_cvt_pk_bf16_f32 v107, v107, v95
    v_fmac_f32_e64 v99, v111, v4
    v_mfma_f32_16x16x32_bf16 v[76:79], v[56:59], v[136:139], v[76:79]
    ds_read_b128 v[48:51], v12 offset:49152
    ds_read_b128 v[52:55], v13 offset:49152
    v_mfma_f32_16x16x32_bf16 v[84:87], v[56:59], v[140:143], v[84:87]
    s_xor_b32 s101, s56, 33562624
    buffer_store_dwordx4 v[120:123], v2, s[20:23], s101 offen sc0 sc1
    v_mfma_f32_16x16x32_bf16 v[80:83], v[60:63], v[140:143], v[80:83]
    v_cvt_pk_bf16_f32 v125, v91, v99
    v_mfma_f32_16x16x32_bf16 v[84:87], v[60:63], v[136:139], v[84:87]
    s_waitcnt lgkmcnt(4)
    v_mov_b32_dpp v127, v107 row_ror:8 row_mask:0xf bank_mask:0xf
    v_mfma_f32_16x16x32_bf16 v[88:91], v[32:35], a[16:19], 0
    ds_read_b128 v[56:59], v12 offset:57344
    ds_read_b128 v[60:63], v13 offset:57344
    v_mfma_f32_16x16x32_bf16 v[96:99], v[32:35], a[20:23], 0
    v_mfma_f32_16x16x32_bf16 v[92:95], v[36:39], a[20:23], 0
    v_sub_f32 v64, v64, v68
    v_sub_f32 v76, v76, v80
    v_mfma_f32_16x16x32_bf16 v[96:99], v[36:39], a[16:19], v[96:99]
    s_waitcnt lgkmcnt(4)
    v_fma_f32 v80, -v76, v4, v64
    v_fma_f32 v68, -v84, v4, v72
    v_mfma_f32_16x16x32_bf16 v[88:91], v[40:43], a[112:115], v[88:91]
    ds_read_b128 v[32:35], v14 offset:32768
    ds_read_b128 v[36:39], v15 offset:32768
    v_mfma_f32_16x16x32_bf16 v[96:99], v[40:43], a[116:119], v[96:99]
    s_xor_b32 s101, s56, 33566720
    buffer_store_dwordx4 v[124:127], v2, s[20:23], s101 offen sc0 sc1
    v_mfma_f32_16x16x32_bf16 v[92:95], v[44:47], a[116:119], v[92:95]
    v_fmac_f32_e64 v64, v76, v4
    v_cvt_pk_bf16_f32 v80, v80, v68
    v_mfma_f32_16x16x32_bf16 v[96:99], v[44:47], a[112:115], v[96:99]
    s_waitcnt lgkmcnt(4)
    v_fmac_f32 v72, v84, v4
    v_cvt_pk_bf16_f32 v16, v64, v72
    v_mfma_f32_16x16x32_bf16 v[88:91], v[48:51], v[240:243], v[88:91]
    ds_read_b128 v[40:43], v14 offset:40960
    ds_read_b128 v[44:47], v15 offset:40960
    v_mfma_f32_16x16x32_bf16 v[96:99], v[48:51], v[244:247], v[96:99]
    v_mov_b32_dpp v18, v80 row_ror:8 row_mask:0xf bank_mask:0xf
    v_mfma_f32_16x16x32_bf16 v[92:95], v[52:55], v[244:247], v[92:95]
    v_sub_f32 v65, v65, v69
    v_sub_f32 v77, v77, v81
    v_mfma_f32_16x16x32_bf16 v[96:99], v[52:55], v[240:243], v[96:99]
    s_waitcnt lgkmcnt(4)
    v_fma_f32 v81, -v77, v4, v65
    v_fma_f32 v69, -v85, v4, v73
    v_mfma_f32_16x16x32_bf16 v[88:91], v[56:59], v[144:147], v[88:91]
    ds_read_b128 v[48:51], v14 offset:49152
    ds_read_b128 v[52:55], v15 offset:49152
    v_mfma_f32_16x16x32_bf16 v[96:99], v[56:59], v[148:151], v[96:99]
    v_fmac_f32 v65, v77, v4
    v_mfma_f32_16x16x32_bf16 v[92:95], v[60:63], v[148:151], v[92:95]
    v_cvt_pk_bf16_f32 v81, v81, v69
    v_fmac_f32 v73, v85, v4
    v_mfma_f32_16x16x32_bf16 v[96:99], v[60:63], v[144:147], v[96:99]
    s_waitcnt lgkmcnt(4)
    v_cvt_pk_bf16_f32 v20, v65, v73
    v_mov_b32_dpp v22, v81 row_ror:8 row_mask:0xf bank_mask:0xf
    v_mfma_f32_16x16x32_bf16 v[100:103], v[32:35], a[24:27], 0
    ds_read_b128 v[56:59], v14 offset:57344
    ds_read_b128 v[60:63], v15 offset:57344
    v_sub_f32 v66, v66, v70
    v_mfma_f32_16x16x32_bf16 v[108:111], v[32:35], a[28:31], 0
    v_sub_f32 v78, v78, v82
    v_fma_f32 v82, -v78, v4, v66
    v_mfma_f32_16x16x32_bf16 v[104:107], v[36:39], a[28:31], 0
    v_fma_f32 v70, -v86, v4, v74
    v_fmac_f32 v66, v78, v4
    v_mfma_f32_16x16x32_bf16 v[108:111], v[36:39], a[24:27], v[108:111]
    s_waitcnt lgkmcnt(4)
    v_add_u32 v8, 4294868992, v8
    v_add_u32 v9, 4294868992, v9
    v_mfma_f32_16x16x32_bf16 v[100:103], v[40:43], a[120:123], v[100:103]
    s_waitcnt vmcnt(20)
    s_barrier
    ds_read_b128 v[32:35], v8 offset:0
    ds_read_b128 v[36:39], v9 offset:0
    v_mfma_f32_16x16x32_bf16 v[108:111], v[40:43], a[124:127], v[108:111]
    v_cvt_pk_bf16_f32 v82, v82, v70
    v_mfma_f32_16x16x32_bf16 v[104:107], v[44:47], a[124:127], v[104:107]
    v_fmac_f32 v74, v86, v4
    v_cvt_pk_bf16_f32 v24, v66, v74
    v_mfma_f32_16x16x32_bf16 v[108:111], v[44:47], a[120:123], v[108:111]
    s_waitcnt lgkmcnt(4)
    v_mov_b32_dpp v26, v82 row_ror:8 row_mask:0xf bank_mask:0xf
    v_sub_f32 v67, v67, v71
    v_mfma_f32_16x16x32_bf16 v[100:103], v[48:51], v[248:251], v[100:103]
    ds_read_b128 v[40:43], v8 offset:8192
    ds_read_b128 v[44:47], v9 offset:8192
    v_mfma_f32_16x16x32_bf16 v[108:111], v[48:51], v[252:255], v[108:111]
    v_mfma_f32_16x16x32_bf16 v[104:107], v[52:55], v[252:255], v[104:107]
    v_sub_f32 v79, v79, v83
    v_fma_f32 v83, -v79, v4, v67
    v_mfma_f32_16x16x32_bf16 v[108:111], v[52:55], v[248:251], v[108:111]
    s_waitcnt lgkmcnt(4)
    v_fma_f32 v71, -v87, v4, v75
    v_fmac_f32 v67, v79, v4
    v_mfma_f32_16x16x32_bf16 v[100:103], v[56:59], v[152:155], v[100:103]
    ds_read_b128 v[48:51], v8 offset:16384
    ds_read_b128 v[52:55], v9 offset:16384
    v_mfma_f32_16x16x32_bf16 v[108:111], v[56:59], v[156:159], v[108:111]
    v_mfma_f32_16x16x32_bf16 v[104:107], v[60:63], v[156:159], v[104:107]
    s_add_u32 m0, s55, 98304
    v_cvt_pk_bf16_f32 v83, v83, v71
    v_fmac_f32 v75, v87, v4
    v_mfma_f32_16x16x32_bf16 v[108:111], v[60:63], v[152:155], v[108:111]
    s_waitcnt lgkmcnt(4)
    v_cvt_pk_bf16_f32 v28, v67, v75
    v_mov_b32_dpp v30, v83 row_ror:8 row_mask:0xf bank_mask:0xf
    v_mfma_f32_16x16x32_bf16 v[64:67], v[32:35], a[32:35], 0
    ds_read_b128 v[56:59], v8 offset:24576
    ds_read_b128 v[60:63], v9 offset:24576
    v_sub_f32 v88, v88, v92
    v_mfma_f32_16x16x32_bf16 v[72:75], v[32:35], a[36:39], 0
    s_add_u32 s100, s54, 163840
    buffer_load_dwordx4 v6, s[20:23], s100 offen offset:0 sc1 lds
    v_sub_f32 v100, v100, v104
    v_mfma_f32_16x16x32_bf16 v[68:71], v[36:39], a[36:39], 0
    v_fma_f32 v104, -v100, v4, v88
    v_fma_f32 v92, -v108, v4, v96
    v_mfma_f32_16x16x32_bf16 v[72:75], v[36:39], a[32:35], v[72:75]
    s_waitcnt lgkmcnt(4)
    v_add_u32 v10, 4294868992, v10
    v_add_u32 v11, 4294868992, v11
    v_mfma_f32_16x16x32_bf16 v[64:67], v[40:43], a[128:131], v[64:67]
    ds_read_b128 v[32:35], v10 offset:0
    ds_read_b128 v[36:39], v11 offset:0
    v_mfma_f32_16x16x32_bf16 v[72:75], v[40:43], a[132:135], v[72:75]
    v_fmac_f32 v88, v100, v4
    v_cvt_pk_bf16_f32 v104, v104, v92
    v_mfma_f32_16x16x32_bf16 v[68:71], v[44:47], a[132:135], v[68:71]
    v_fmac_f32 v96, v108, v4
    v_cvt_pk_bf16_f32 v17, v88, v96
    v_mfma_f32_16x16x32_bf16 v[72:75], v[44:47], a[128:131], v[72:75]
    s_waitcnt lgkmcnt(4)
    v_mov_b32_dpp v19, v104 row_ror:8 row_mask:0xf bank_mask:0xf
    v_sub_f32_e64 v89, v89, v93
    v_mfma_f32_16x16x32_bf16 v[64:67], v[48:51], a[192:195], v[64:67]
    ds_read_b128 v[40:43], v10 offset:8192
    ds_read_b128 v[44:47], v11 offset:8192
    v_mfma_f32_16x16x32_bf16 v[72:75], v[48:51], a[196:199], v[72:75]
    v_sub_f32_e64 v101, v101, v105
    v_fma_f32 v105, -v101, v4, v89
    v_mfma_f32_16x16x32_bf16 v[68:71], v[52:55], a[196:199], v[68:71]
    v_fma_f32 v93, -v109, v4, v97
    v_fmac_f32 v89, v101, v4
    v_mfma_f32_16x16x32_bf16 v[72:75], v[52:55], a[192:195], v[72:75]
    s_waitcnt lgkmcnt(4)
    v_cvt_pk_bf16_f32 v105, v105, v93
    v_fmac_f32_e64 v97, v109, v4
    v_mfma_f32_16x16x32_bf16 v[64:67], v[56:59], v[160:163], v[64:67]
    ds_read_b128 v[48:51], v10 offset:16384
    ds_read_b128 v[52:55], v11 offset:16384
    v_mfma_f32_16x16x32_bf16 v[72:75], v[56:59], v[164:167], v[72:75]
    s_xor_b32 s101, s56, 50331648
    buffer_store_dwordx4 v[16:19], v2, s[20:23], s101 offen sc0 sc1
    v_mfma_f32_16x16x32_bf16 v[68:71], v[60:63], v[164:167], v[68:71]
    v_cvt_pk_bf16_f32 v21, v89, v97
    v_mov_b32_dpp v23, v105 row_ror:8 row_mask:0xf bank_mask:0xf
    v_mfma_f32_16x16x32_bf16 v[72:75], v[60:63], v[160:163], v[72:75]
    s_waitcnt lgkmcnt(4)
    v_sub_f32 v90, v90, v94
    v_sub_f32_e64 v102, v102, v106
    v_mfma_f32_16x16x32_bf16 v[76:79], v[32:35], a[40:43], 0
    ds_read_b128 v[56:59], v10 offset:24576
    ds_read_b128 v[60:63], v11 offset:24576
    v_fma_f32 v106, -v102, v4, v90
    v_mfma_f32_16x16x32_bf16 v[84:87], v[32:35], a[44:47], 0
    buffer_load_dwordx4 v6, s[20:23], s100 offen offset:1024 sc1 lds
    v_fma_f32 v94, -v110, v4, v98
    v_mfma_f32_16x16x32_bf16 v[80:83], v[36:39], a[44:47], 0
    v_fmac_f32 v90, v102, v4
    v_cvt_pk_bf16_f32 v106, v106, v94
    v_mfma_f32_16x16x32_bf16 v[84:87], v[36:39], a[40:43], v[84:87]
    s_waitcnt lgkmcnt(4)
    v_add_u32 v12, 4294868992, v12
    v_add_u32 v13, 4294868992, v13
    v_mfma_f32_16x16x32_bf16 v[76:79], v[40:43], a[136:139], v[76:79]
    ds_read_b128 v[32:35], v12 offset:0
    ds_read_b128 v[36:39], v13 offset:0
    v_mfma_f32_16x16x32_bf16 v[84:87], v[40:43], a[140:143], v[84:87]
    s_xor_b32 s101, s56, 50335744
    buffer_store_dwordx4 v[20:23], v2, s[20:23], s101 offen sc0 sc1
    v_mfma_f32_16x16x32_bf16 v[80:83], v[44:47], a[140:143], v[80:83]
    v_fmac_f32_e64 v98, v110, v4
    v_cvt_pk_bf16_f32 v25, v90, v98
    v_mfma_f32_16x16x32_bf16 v[84:87], v[44:47], a[136:139], v[84:87]
    s_waitcnt lgkmcnt(4)
    v_mov_b32_dpp v27, v106 row_ror:8 row_mask:0xf bank_mask:0xf
    v_sub_f32 v91, v91, v95
    v_mfma_f32_16x16x32_bf16 v[76:79], v[48:51], a[200:203], v[76:79]
    ds_read_b128 v[40:43], v12 offset:8192
    ds_read_b128 v[44:47], v13 offset:8192
    v_mfma_f32_16x16x32_bf16 v[84:87], v[48:51], a[204:207], v[84:87]
    v_sub_f32_e64 v103, v103, v107
    v_mfma_f32_16x16x32_bf16 v[80:83], v[52:55], a[204:207], v[80:83]
    v_fma_f32 v107, -v103, v4, v91
    v_fma_f32 v95, -v111, v4, v99
    v_mfma_f32_16x16x32_bf16 v[84:87], v[52:55], a[200:203], v[84:87]
    s_waitcnt lgkmcnt(4)
    v_fmac_f32 v91, v103, v4
    v_cvt_pk_bf16_f32 v107, v107, v95
    v_mfma_f32_16x16x32_bf16 v[76:79], v[56:59], v[168:171], v[76:79]
    ds_read_b128 v[48:51], v12 offset:16384
    ds_read_b128 v[52:55], v13 offset:16384
    v_mfma_f32_16x16x32_bf16 v[84:87], v[56:59], v[172:175], v[84:87]
    s_xor_b32 s101, s56, 50339840
    buffer_store_dwordx4 v[24:27], v2, s[20:23], s101 offen sc0 sc1
    v_mfma_f32_16x16x32_bf16 v[80:83], v[60:63], v[172:175], v[80:83]
    v_fmac_f32 v99, v111, v4
    v_cvt_pk_bf16_f32 v29, v91, v99
    v_mfma_f32_16x16x32_bf16 v[84:87], v[60:63], v[168:171], v[84:87]
    s_waitcnt lgkmcnt(4)
    v_mov_b32_dpp v31, v107 row_ror:8 row_mask:0xf bank_mask:0xf
    v_mfma_f32_16x16x32_bf16 v[88:91], v[32:35], a[48:51], 0
    ds_read_b128 v[56:59], v12 offset:24576
    ds_read_b128 v[60:63], v13 offset:24576
    v_sub_f32 v64, v64, v68
    v_mfma_f32_16x16x32_bf16 v[96:99], v[32:35], a[52:55], 0
    buffer_load_dwordx4 v6, s[20:23], s100 offen offset:2048 sc1 lds
    v_sub_f32_e64 v76, v76, v80
    v_mfma_f32_16x16x32_bf16 v[92:95], v[36:39], a[52:55], 0
    v_fma_f32 v80, -v76, v4, v64
    v_fma_f32 v68, -v84, v4, v72
    v_mfma_f32_16x16x32_bf16 v[96:99], v[36:39], a[48:51], v[96:99]
    s_waitcnt lgkmcnt(4)
    v_add_u32 v14, 4294868992, v14
    v_add_u32 v15, 4294868992, v15
    v_mfma_f32_16x16x32_bf16 v[88:91], v[40:43], a[144:147], v[88:91]
    ds_read_b128 v[32:35], v14 offset:0
    ds_read_b128 v[36:39], v15 offset:0
    v_mfma_f32_16x16x32_bf16 v[96:99], v[40:43], a[148:151], v[96:99]
    s_xor_b32 s101, s56, 50343936
    buffer_store_dwordx4 v[28:31], v2, s[20:23], s101 offen sc0 sc1
    v_mfma_f32_16x16x32_bf16 v[92:95], v[44:47], a[148:151], v[92:95]
    v_fmac_f32 v64, v76, v4
    v_cvt_pk_bf16_f32 v80, v80, v68
    v_mfma_f32_16x16x32_bf16 v[96:99], v[44:47], a[144:147], v[96:99]
    s_waitcnt lgkmcnt(4)
    v_fmac_f32_e64 v72, v84, v4
    v_cvt_pk_bf16_f32 v112, v64, v72
    v_mfma_f32_16x16x32_bf16 v[88:91], v[48:51], a[208:211], v[88:91]
    ds_read_b128 v[40:43], v14 offset:8192
    ds_read_b128 v[44:47], v15 offset:8192
    v_mfma_f32_16x16x32_bf16 v[96:99], v[48:51], a[212:215], v[96:99]
    v_mov_b32_dpp v114, v80 row_ror:8 row_mask:0xf bank_mask:0xf
    v_mfma_f32_16x16x32_bf16 v[92:95], v[52:55], a[212:215], v[92:95]
    v_sub_f32 v65, v65, v69
    v_sub_f32_e64 v77, v77, v81
    v_mfma_f32_16x16x32_bf16 v[96:99], v[52:55], a[208:211], v[96:99]
    s_waitcnt lgkmcnt(4)
    v_fma_f32 v81, -v77, v4, v65
    v_fma_f32 v69, -v85, v4, v73
    v_mfma_f32_16x16x32_bf16 v[88:91], v[56:59], v[176:179], v[88:91]
    ds_read_b128 v[48:51], v14 offset:16384
    ds_read_b128 v[52:55], v15 offset:16384
    v_mfma_f32_16x16x32_bf16 v[96:99], v[56:59], v[180:183], v[96:99]
    v_fmac_f32_e64 v65, v77, v4
    v_mfma_f32_16x16x32_bf16 v[92:95], v[60:63], v[180:183], v[92:95]
    v_cvt_pk_bf16_f32 v81, v81, v69
    v_fmac_f32 v73, v85, v4
    v_mfma_f32_16x16x32_bf16 v[96:99], v[60:63], v[176:179], v[96:99]
    s_waitcnt lgkmcnt(4)
    v_cvt_pk_bf16_f32 v116, v65, v73
    v_mov_b32_dpp v118, v81 row_ror:8 row_mask:0xf bank_mask:0xf
    v_mfma_f32_16x16x32_bf16 v[100:103], v[32:35], a[56:59], 0
    ds_read_b128 v[56:59], v14 offset:24576
    ds_read_b128 v[60:63], v15 offset:24576
    v_mfma_f32_16x16x32_bf16 v[108:111], v[32:35], a[60:63], 0
    buffer_load_dwordx4 v6, s[20:23], s100 offen offset:3072 sc1 lds
    v_mfma_f32_16x16x32_bf16 v[104:107], v[36:39], a[60:63], 0
    v_sub_f32 v66, v66, v70
    v_sub_f32 v78, v78, v82
    v_mfma_f32_16x16x32_bf16 v[108:111], v[36:39], a[56:59], v[108:111]
    s_waitcnt lgkmcnt(4)
    v_fma_f32 v82, -v78, v4, v66
    v_fma_f32 v70, -v86, v4, v74
    v_mfma_f32_16x16x32_bf16 v[100:103], v[40:43], a[152:155], v[100:103]
    s_waitcnt vmcnt(20)
    s_barrier
    ds_read_b128 v[32:35], v8 offset:32768
    ds_read_b128 v[36:39], v9 offset:32768
    v_mfma_f32_16x16x32_bf16 v[108:111], v[40:43], a[156:159], v[108:111]
    v_fmac_f32 v66, v78, v4
    v_mfma_f32_16x16x32_bf16 v[104:107], v[44:47], a[156:159], v[104:107]
    v_cvt_pk_bf16_f32 v82, v82, v70
    v_fmac_f32 v74, v86, v4
    v_mfma_f32_16x16x32_bf16 v[108:111], v[44:47], a[152:155], v[108:111]
    s_waitcnt lgkmcnt(4)
    v_cvt_pk_bf16_f32 v120, v66, v74
    v_mov_b32_dpp v122, v82 row_ror:8 row_mask:0xf bank_mask:0xf
    v_mfma_f32_16x16x32_bf16 v[100:103], v[48:51], a[216:219], v[100:103]
    ds_read_b128 v[40:43], v8 offset:40960
    ds_read_b128 v[44:47], v9 offset:40960
    v_mfma_f32_16x16x32_bf16 v[108:111], v[48:51], a[220:223], v[108:111]
    v_sub_f32_e64 v67, v67, v71
    v_mfma_f32_16x16x32_bf16 v[104:107], v[52:55], a[220:223], v[104:107]
    v_sub_f32 v79, v79, v83
    v_fma_f32 v83, -v79, v4, v67
    v_mfma_f32_16x16x32_bf16 v[108:111], v[52:55], a[216:219], v[108:111]
    s_waitcnt lgkmcnt(4)
    v_fma_f32 v71, -v87, v4, v75
    v_fmac_f32_e64 v67, v79, v4
    v_mfma_f32_16x16x32_bf16 v[100:103], v[56:59], v[184:187], v[100:103]
    ds_read_b128 v[48:51], v8 offset:49152
    ds_read_b128 v[52:55], v9 offset:49152
    v_mfma_f32_16x16x32_bf16 v[108:111], v[56:59], v[188:191], v[108:111]
    v_mfma_f32_16x16x32_bf16 v[104:107], v[60:63], v[188:191], v[104:107]
    s_add_u32 m0, s55, 102400
    v_cvt_pk_bf16_f32 v83, v83, v71
    v_fmac_f32 v75, v87, v4
    v_mfma_f32_16x16x32_bf16 v[108:111], v[60:63], v[184:187], v[108:111]
    s_waitcnt lgkmcnt(4)
    v_cvt_pk_bf16_f32 v124, v67, v75
    v_mov_b32_dpp v126, v83 row_ror:8 row_mask:0xf bank_mask:0xf
    v_mfma_f32_16x16x32_bf16 v[64:67], v[32:35], a[32:35], 0
    ds_read_b128 v[56:59], v8 offset:57344
    ds_read_b128 v[60:63], v9 offset:57344
    v_mfma_f32_16x16x32_bf16 v[72:75], v[32:35], a[36:39], 0
    s_add_u32 s100, s54, 167936
    buffer_load_dwordx4 v6, s[20:23], s100 offen offset:0 sc1 lds
    v_mfma_f32_16x16x32_bf16 v[68:71], v[36:39], a[36:39], 0
    v_sub_f32_e64 v88, v88, v92
    v_sub_f32 v100, v100, v104
    v_mfma_f32_16x16x32_bf16 v[72:75], v[36:39], a[32:35], v[72:75]
    s_waitcnt lgkmcnt(4)
    v_fma_f32 v104, -v100, v4, v88
    v_fma_f32 v92, -v108, v4, v96
    v_mfma_f32_16x16x32_bf16 v[64:67], v[40:43], a[128:131], v[64:67]
    ds_read_b128 v[32:35], v10 offset:32768
    ds_read_b128 v[36:39], v11 offset:32768
    v_mfma_f32_16x16x32_bf16 v[72:75], v[40:43], a[132:135], v[72:75]
    v_fmac_f32 v88, v100, v4
    v_cvt_pk_bf16_f32 v104, v104, v92
    v_mfma_f32_16x16x32_bf16 v[68:71], v[44:47], a[132:135], v[68:71]
    v_fmac_f32 v96, v108, v4
    v_cvt_pk_bf16_f32 v113, v88, v96
    v_mfma_f32_16x16x32_bf16 v[72:75], v[44:47], a[128:131], v[72:75]
    s_waitcnt lgkmcnt(4)
    v_mov_b32_dpp v115, v104 row_ror:8 row_mask:0xf bank_mask:0xf
    v_sub_f32 v89, v89, v93
    v_mfma_f32_16x16x32_bf16 v[64:67], v[48:51], a[192:195], v[64:67]
    ds_read_b128 v[40:43], v10 offset:40960
    ds_read_b128 v[44:47], v11 offset:40960
    v_mfma_f32_16x16x32_bf16 v[72:75], v[48:51], a[196:199], v[72:75]
    v_sub_f32_e64 v101, v101, v105
    v_fma_f32 v105, -v101, v4, v89
    v_mfma_f32_16x16x32_bf16 v[68:71], v[52:55], a[196:199], v[68:71]
    v_fma_f32 v93, -v109, v4, v97
    v_fmac_f32_e64 v89, v101, v4
    v_mfma_f32_16x16x32_bf16 v[72:75], v[52:55], a[192:195], v[72:75]
    s_waitcnt lgkmcnt(4)
    v_cvt_pk_bf16_f32 v105, v105, v93
    v_fmac_f32 v97, v109, v4
    v_mfma_f32_16x16x32_bf16 v[64:67], v[56:59], v[160:163], v[64:67]
    ds_read_b128 v[48:51], v10 offset:49152
    ds_read_b128 v[52:55], v11 offset:49152
    v_mfma_f32_16x16x32_bf16 v[72:75], v[56:59], v[164:167], v[72:75]
    s_xor_b32 s101, s56, 34607104
    buffer_store_dwordx4 v[112:115], v2, s[20:23], s101 offen sc0 sc1
    v_mfma_f32_16x16x32_bf16 v[68:71], v[60:63], v[164:167], v[68:71]
    v_cvt_pk_bf16_f32 v117, v89, v97
    v_mov_b32_dpp v119, v105 row_ror:8 row_mask:0xf bank_mask:0xf
    v_mfma_f32_16x16x32_bf16 v[72:75], v[60:63], v[160:163], v[72:75]
    s_waitcnt lgkmcnt(4)
    v_sub_f32 v90, v90, v94
    v_sub_f32_e64 v102, v102, v106
    v_mfma_f32_16x16x32_bf16 v[76:79], v[32:35], a[40:43], 0
    ds_read_b128 v[56:59], v10 offset:57344
    ds_read_b128 v[60:63], v11 offset:57344
    v_mfma_f32_16x16x32_bf16 v[84:87], v[32:35], a[44:47], 0
    buffer_load_dwordx4 v6, s[20:23], s100 offen offset:1024 sc1 lds
    v_mfma_f32_16x16x32_bf16 v[80:83], v[36:39], a[44:47], 0
    v_fma_f32 v106, -v102, v4, v90
    v_fma_f32 v94, -v110, v4, v98
    v_mfma_f32_16x16x32_bf16 v[84:87], v[36:39], a[40:43], v[84:87]
    s_waitcnt lgkmcnt(4)
    v_fmac_f32 v90, v102, v4
    v_cvt_pk_bf16_f32 v106, v106, v94
    v_mfma_f32_16x16x32_bf16 v[76:79], v[40:43], a[136:139], v[76:79]
    ds_read_b128 v[32:35], v12 offset:32768
    ds_read_b128 v[36:39], v13 offset:32768
    v_mfma_f32_16x16x32_bf16 v[84:87], v[40:43], a[140:143], v[84:87]
    s_xor_b32 s101, s56, 34603008
    buffer_store_dwordx4 v[116:119], v2, s[20:23], s101 offen sc0 sc1
    v_mfma_f32_16x16x32_bf16 v[80:83], v[44:47], a[140:143], v[80:83]
    v_fmac_f32 v98, v110, v4
    v_cvt_pk_bf16_f32 v121, v90, v98
    v_mfma_f32_16x16x32_bf16 v[84:87], v[44:47], a[136:139], v[84:87]
    s_waitcnt lgkmcnt(4)
    v_mov_b32_dpp v123, v106 row_ror:8 row_mask:0xf bank_mask:0xf
    v_sub_f32_e64 v91, v91, v95
    v_mfma_f32_16x16x32_bf16 v[76:79], v[48:51], a[200:203], v[76:79]
    ds_read_b128 v[40:43], v12 offset:40960
    ds_read_b128 v[44:47], v13 offset:40960
    v_mfma_f32_16x16x32_bf16 v[84:87], v[48:51], a[204:207], v[84:87]
    v_sub_f32_e64 v103, v103, v107
    v_mfma_f32_16x16x32_bf16 v[80:83], v[52:55], a[204:207], v[80:83]
    v_fma_f32 v107, -v103, v4, v91
    v_fma_f32 v95, -v111, v4, v99
    v_mfma_f32_16x16x32_bf16 v[84:87], v[52:55], a[200:203], v[84:87]
    s_waitcnt lgkmcnt(4)
    v_fmac_f32 v91, v103, v4
    v_cvt_pk_bf16_f32 v107, v107, v95
    v_mfma_f32_16x16x32_bf16 v[76:79], v[56:59], v[168:171], v[76:79]
    ds_read_b128 v[48:51], v12 offset:49152
    ds_read_b128 v[52:55], v13 offset:49152
    v_mfma_f32_16x16x32_bf16 v[84:87], v[56:59], v[172:175], v[84:87]
    s_xor_b32 s101, s56, 34615296
    buffer_store_dwordx4 v[120:123], v2, s[20:23], s101 offen sc0 sc1
    v_mfma_f32_16x16x32_bf16 v[80:83], v[60:63], v[172:175], v[80:83]
    v_fmac_f32 v99, v111, v4
    v_cvt_pk_bf16_f32 v125, v91, v99
    v_mfma_f32_16x16x32_bf16 v[84:87], v[60:63], v[168:171], v[84:87]
    s_waitcnt lgkmcnt(4)
    v_mov_b32_dpp v127, v107 row_ror:8 row_mask:0xf bank_mask:0xf
    v_mfma_f32_16x16x32_bf16 v[88:91], v[32:35], a[48:51], 0
    ds_read_b128 v[56:59], v12 offset:57344
    ds_read_b128 v[60:63], v13 offset:57344
    v_mfma_f32_16x16x32_bf16 v[96:99], v[32:35], a[52:55], 0
    s_waitcnt vmcnt(6)
    s_barrier
    s_cmp_lg_u32 s40, 0
    s_cbranch_scc1 Larr0
    s_add_u32 s52, s61, 49152
    v_mov_b32 v7, 1
    s_mov_b64 exec, 1
    buffer_atomic_add v7, off, s[20:23], s52 sc0 sc1
    s_mov_b64 exec, -1
Larr0:
    buffer_load_dwordx4 v6, s[20:23], s100 offen offset:2048 sc1 lds
    v_mfma_f32_16x16x32_bf16 v[92:95], v[36:39], a[52:55], 0
    v_sub_f32 v64, v64, v68
    v_sub_f32 v76, v76, v80
    v_mfma_f32_16x16x32_bf16 v[96:99], v[36:39], a[48:51], v[96:99]
    s_waitcnt lgkmcnt(4)
    v_fma_f32 v80, -v76, v4, v64
    v_fma_f32 v68, -v84, v4, v72
    v_mfma_f32_16x16x32_bf16 v[88:91], v[40:43], a[144:147], v[88:91]
    ds_read_b128 v[32:35], v14 offset:32768
    ds_read_b128 v[36:39], v15 offset:32768
    v_mfma_f32_16x16x32_bf16 v[96:99], v[40:43], a[148:151], v[96:99]
    s_xor_b32 s101, s56, 34611200
    buffer_store_dwordx4 v[124:127], v2, s[20:23], s101 offen sc0 sc1
    v_mfma_f32_16x16x32_bf16 v[92:95], v[44:47], a[148:151], v[92:95]
    v_fmac_f32_e64 v64, v76, v4
    v_cvt_pk_bf16_f32 v80, v80, v68
    v_mfma_f32_16x16x32_bf16 v[96:99], v[44:47], a[144:147], v[96:99]
    s_waitcnt lgkmcnt(4)
    v_fmac_f32 v72, v84, v4
    v_cvt_pk_bf16_f32 v16, v64, v72
    v_mfma_f32_16x16x32_bf16 v[88:91], v[48:51], a[208:211], v[88:91]
    ds_read_b128 v[40:43], v14 offset:40960
    ds_read_b128 v[44:47], v15 offset:40960
    v_mfma_f32_16x16x32_bf16 v[96:99], v[48:51], a[212:215], v[96:99]
    v_mov_b32_dpp v18, v80 row_ror:8 row_mask:0xf bank_mask:0xf
    v_mfma_f32_16x16x32_bf16 v[92:95], v[52:55], a[212:215], v[92:95]
    v_sub_f32 v65, v65, v69
    v_sub_f32 v77, v77, v81
    v_mfma_f32_16x16x32_bf16 v[96:99], v[52:55], a[208:211], v[96:99]
    s_waitcnt lgkmcnt(4)
    v_fma_f32 v81, -v77, v4, v65
    v_fma_f32 v69, -v85, v4, v73
    v_mfma_f32_16x16x32_bf16 v[88:91], v[56:59], v[176:179], v[88:91]
    ds_read_b128 v[48:51], v14 offset:49152
    ds_read_b128 v[52:55], v15 offset:49152
    v_mfma_f32_16x16x32_bf16 v[96:99], v[56:59], v[180:183], v[96:99]
    v_fmac_f32 v65, v77, v4
    v_mfma_f32_16x16x32_bf16 v[92:95], v[60:63], v[180:183], v[92:95]
    v_cvt_pk_bf16_f32 v81, v81, v69
    v_fmac_f32 v73, v85, v4
    v_mfma_f32_16x16x32_bf16 v[96:99], v[60:63], v[176:179], v[96:99]
    s_waitcnt lgkmcnt(4)
    v_cvt_pk_bf16_f32 v20, v65, v73
    v_mov_b32_dpp v22, v81 row_ror:8 row_mask:0xf bank_mask:0xf
    v_mfma_f32_16x16x32_bf16 v[100:103], v[32:35], a[56:59], 0
    ds_read_b128 v[56:59], v14 offset:57344
    ds_read_b128 v[60:63], v15 offset:57344
    v_sub_f32_e64 v66, v66, v70
    v_mfma_f32_16x16x32_bf16 v[108:111], v[32:35], a[60:63], 0
    buffer_load_dwordx4 v6, s[20:23], s100 offen offset:3072 sc1 lds
    v_sub_f32_e64 v78, v78, v82
    v_mfma_f32_16x16x32_bf16 v[104:107], v[36:39], a[60:63], 0
    v_fma_f32 v82, -v78, v4, v66
    v_fma_f32 v70, -v86, v4, v74
    v_mfma_f32_16x16x32_bf16 v[108:111], v[36:39], a[56:59], v[108:111]
    s_waitcnt lgkmcnt(4)
    v_add_u32 v8, 65536, v8
    v_add_u32 v9, 65536, v9
    v_mfma_f32_16x16x32_bf16 v[100:103], v[40:43], a[152:155], v[100:103]
    s_waitcnt vmcnt(20)
    s_barrier
    ds_read_b128 v[32:35], v8 offset:0
    ds_read_b128 v[36:39], v9 offset:0
    v_mfma_f32_16x16x32_bf16 v[108:111], v[40:43], a[156:159], v[108:111]
    v_fmac_f32 v66, v78, v4
    v_mfma_f32_16x16x32_bf16 v[104:107], v[44:47], a[156:159], v[104:107]
    v_cvt_pk_bf16_f32 v82, v82, v70
    v_fmac_f32 v74, v86, v4
    v_mfma_f32_16x16x32_bf16 v[108:111], v[44:47], a[152:155], v[108:111]
    s_waitcnt lgkmcnt(4)
    v_cvt_pk_bf16_f32 v24, v66, v74
    v_mov_b32_dpp v26, v82 row_ror:8 row_mask:0xf bank_mask:0xf
    v_mfma_f32_16x16x32_bf16 v[100:103], v[48:51], a[216:219], v[100:103]
    ds_read_b128 v[40:43], v8 offset:8192
    ds_read_b128 v[44:47], v9 offset:8192
    v_mfma_f32_16x16x32_bf16 v[108:111], v[48:51], a[220:223], v[108:111]
    v_sub_f32 v67, v67, v71
    v_mfma_f32_16x16x32_bf16 v[104:107], v[52:55], a[220:223], v[104:107]
    v_sub_f32 v79, v79, v83
    v_fma_f32 v83, -v79, v4, v67
    v_mfma_f32_16x16x32_bf16 v[108:111], v[52:55], a[216:219], v[108:111]
    s_waitcnt lgkmcnt(4)
    v_fma_f32 v71, -v87, v4, v75
    v_fmac_f32 v67, v79, v4
    v_mfma_f32_16x16x32_bf16 v[100:103], v[56:59], v[184:187], v[100:103]
    ds_read_b128 v[48:51], v8 offset:16384
    ds_read_b128 v[52:55], v9 offset:16384
    v_mfma_f32_16x16x32_bf16 v[108:111], v[56:59], v[188:191], v[108:111]
    v_mfma_f32_16x16x32_bf16 v[104:107], v[60:63], v[188:191], v[104:107]
    s_add_u32 m0, s65, 131072
    v_cvt_pk_bf16_f32 v83, v83, v71
    v_fmac_f32 v75, v87, v4
    v_mfma_f32_16x16x32_bf16 v[108:111], v[60:63], v[184:187], v[108:111]
    s_waitcnt lgkmcnt(4)
    v_cvt_pk_bf16_f32 v28, v67, v75
    v_mov_b32_dpp v30, v83 row_ror:8 row_mask:0xf bank_mask:0xf
    v_mfma_f32_16x16x32_bf16 v[64:67], v[32:35], a[64:67], 0
    ds_read_b128 v[56:59], v8 offset:24576
    ds_read_b128 v[60:63], v9 offset:24576
    v_sub_f32 v88, v88, v92
    v_mfma_f32_16x16x32_bf16 v[72:75], v[32:35], a[68:71], 0
    s_add_u32 s60, s48, 0
    buffer_load_dwordx4 v3, s[32:35], s60 offen lds
    v_sub_f32 v100, v100, v104
    v_mfma_f32_16x16x32_bf16 v[68:71], v[36:39], a[68:71], 0
    v_fma_f32 v104, -v100, v4, v88
    v_fma_f32 v92, -v108, v4, v96
    v_mfma_f32_16x16x32_bf16 v[72:75], v[36:39], a[64:67], v[72:75]
    s_waitcnt lgkmcnt(4)
    v_add_u32 v10, 65536, v10
    v_add_u32 v11, 65536, v11
    v_mfma_f32_16x16x32_bf16 v[64:67], v[40:43], a[160:163], v[64:67]
    ds_read_b128 v[32:35], v10 offset:0
    ds_read_b128 v[36:39], v11 offset:0
    v_mfma_f32_16x16x32_bf16 v[72:75], v[40:43], a[164:167], v[72:75]
    v_fmac_f32_e64 v88, v100, v4
    v_cvt_pk_bf16_f32 v104, v104, v92
    v_mfma_f32_16x16x32_bf16 v[68:71], v[44:47], a[164:167], v[68:71]
    v_fmac_f32_e64 v96, v108, v4
Lpg5:
    s_cbranch_execz Lback
    v_cvt_pk_bf16_f32 v17, v88, v96
    v_mfma_f32_16x16x32_bf16 v[72:75], v[44:47], a[160:163], v[72:75]
    s_waitcnt lgkmcnt(4)
    v_mov_b32_dpp v19, v104 row_ror:8 row_mask:0xf bank_mask:0xf
    v_sub_f32_e64 v89, v89, v93
    v_mfma_f32_16x16x32_bf16 v[64:67], v[48:51], a[224:227], v[64:67]
    ds_read_b128 v[40:43], v10 offset:8192
    ds_read_b128 v[44:47], v11 offset:8192
    v_mfma_f32_16x16x32_bf16 v[72:75], v[48:51], a[228:231], v[72:75]
    s_cmp_lg_u32 s40, 0
    s_cbranch_scc1 Lrel0
    s_waitcnt vmcnt(4)
    v_readfirstlane_b32 s52, v7
    v_mov_b32 v7, 64
    s_cmp_lg_u32 s52, 63
    s_cbranch_scc1 Lrel0
    s_add_u32 s52, s61, 0
    s_mov_b64 exec, 0xff
    buffer_atomic_add v7, v5, s[20:23], s52 offen sc1
    s_mov_b64 exec, -1
Lrel0:
    v_sub_f32 v101, v101, v105
    v_fma_f32 v105, -v101, v4, v89
    v_mfma_f32_16x16x32_bf16 v[68:71], v[52:55], a[228:231], v[68:71]
    v_fma_f32 v93, -v109, v4, v97
    v_fmac_f32_e64 v89, v101, v4
    v_mfma_f32_16x16x32_bf16 v[72:75], v[52:55], a[224:227], v[72:75]
    s_waitcnt lgkmcnt(4)
    v_cvt_pk_bf16_f32 v105, v105, v93
    v_fmac_f32 v97, v109, v4
    v_mfma_f32_16x16x32_bf16 v[64:67], v[56:59], v[192:195], v[64:67]
    ds_read_b128 v[48:51], v10 offset:16384
    ds_read_b128 v[52:55], v11 offset:16384
    v_mfma_f32_16x16x32_bf16 v[72:75], v[56:59], v[196:199], v[72:75]
    s_xor_b32 s101, s56, 51384320
    buffer_store_dwordx4 v[16:19], v2, s[20:23], s101 offen sc0 sc1
    v_mfma_f32_16x16x32_bf16 v[68:71], v[60:63], v[196:199], v[68:71]
    s_add_u32 m0, s65, 135168
    v_cvt_pk_bf16_f32 v21, v89, v97
    v_mov_b32_dpp v23, v105 row_ror:8 row_mask:0xf bank_mask:0xf
    v_mfma_f32_16x16x32_bf16 v[72:75], v[60:63], v[192:195], v[72:75]
    s_waitcnt lgkmcnt(4)
    v_sub_f32 v90, v90, v94
    v_sub_f32_e64 v102, v102, v106
    v_mfma_f32_16x16x32_bf16 v[76:79], v[32:35], a[72:75], 0
    ds_read_b128 v[56:59], v10 offset:24576
    ds_read_b128 v[60:63], v11 offset:24576
    v_fma_f32 v106, -v102, v4, v90
    v_mfma_f32_16x16x32_bf16 v[84:87], v[32:35], a[76:79], 0
    s_add_u32 s60, s48, 16384
    buffer_load_dwordx4 v3, s[32:35], s60 offen lds
    v_fma_f32 v94, -v110, v4, v98
    v_mfma_f32_16x16x32_bf16 v[80:83], v[36:39], a[76:79], 0
    v_fmac_f32 v90, v102, v4
    v_cvt_pk_bf16_f32 v106, v106, v94
    v_mfma_f32_16x16x32_bf16 v[84:87], v[36:39], a[72:75], v[84:87]
    s_waitcnt lgkmcnt(4)
    v_add_u32 v12, 65536, v12
    v_add_u32 v13, 65536, v13
    v_mfma_f32_16x16x32_bf16 v[76:79], v[40:43], a[168:171], v[76:79]
    ds_read_b128 v[32:35], v12 offset:0
    ds_read_b128 v[36:39], v13 offset:0
    v_mfma_f32_16x16x32_bf16 v[84:87], v[40:43], a[172:175], v[84:87]
    s_xor_b32 s101, s56, 51380224
    buffer_store_dwordx4 v[20:23], v2, s[20:23], s101 offen sc0 sc1
    v_mfma_f32_16x16x32_bf16 v[80:83], v[44:47], a[172:175], v[80:83]
    v_fmac_f32 v98, v110, v4
    v_cvt_pk_bf16_f32 v25, v90, v98
    v_mfma_f32_16x16x32_bf16 v[84:87], v[44:47], a[168:171], v[84:87]
    s_waitcnt lgkmcnt(4)
    v_mov_b32_dpp v27, v106 row_ror:8 row_mask:0xf bank_mask:0xf
    v_sub_f32_e64 v91, v91, v95
    v_mfma_f32_16x16x32_bf16 v[76:79], v[48:51], a[232:235], v[76:79]
    ds_read_b128 v[40:43], v12 offset:8192
    ds_read_b128 v[44:47], v13 offset:8192
    v_mfma_f32_16x16x32_bf16 v[84:87], v[48:51], a[236:239], v[84:87]
    v_sub_f32_e64 v103, v103, v107
    v_mfma_f32_16x16x32_bf16 v[80:83], v[52:55], a[236:239], v[80:83]
    v_fma_f32 v107, -v103, v4, v91
    v_fma_f32 v95, -v111, v4, v99
    v_mfma_f32_16x16x32_bf16 v[84:87], v[52:55], a[232:235], v[84:87]
    s_waitcnt lgkmcnt(4)
    v_fmac_f32 v91, v103, v4
    v_cvt_pk_bf16_f32 v107, v107, v95
    v_mfma_f32_16x16x32_bf16 v[76:79], v[56:59], v[200:203], v[76:79]
    ds_read_b128 v[48:51], v12 offset:16384
    ds_read_b128 v[52:55], v13 offset:16384
    v_mfma_f32_16x16x32_bf16 v[84:87], v[56:59], v[204:207], v[84:87]
    s_xor_b32 s101, s56, 51392512
    buffer_store_dwordx4 v[24:27], v2, s[20:23], s101 offen sc0 sc1
    v_mfma_f32_16x16x32_bf16 v[80:83], v[60:63], v[204:207], v[80:83]
    s_add_u32 m0, s65, 139264
    v_fmac_f32 v99, v111, v4
    v_cvt_pk_bf16_f32 v29, v91, v99
    v_mfma_f32_16x16x32_bf16 v[84:87], v[60:63], v[200:203], v[84:87]
    s_waitcnt lgkmcnt(4)
    v_mov_b32_dpp v31, v107 row_ror:8 row_mask:0xf bank_mask:0xf
    v_mfma_f32_16x16x32_bf16 v[88:91], v[32:35], a[80:83], 0
    ds_read_b128 v[56:59], v12 offset:24576
    ds_read_b128 v[60:63], v13 offset:24576
    v_sub_f32_e64 v64, v64, v68
    v_mfma_f32_16x16x32_bf16 v[96:99], v[32:35], a[84:87], 0
    s_add_u32 s60, s48, 32768
    buffer_load_dwordx4 v3, s[32:35], s60 offen lds
    v_sub_f32 v76, v76, v80
    v_mfma_f32_16x16x32_bf16 v[92:95], v[36:39], a[84:87], 0
    v_fma_f32 v80, -v76, v4, v64
    v_fma_f32 v68, -v84, v4, v72
    v_mfma_f32_16x16x32_bf16 v[96:99], v[36:39], a[80:83], v[96:99]
    s_waitcnt lgkmcnt(4)
    v_add_u32 v14, 65536, v14
    v_add_u32 v15, 65536, v15
    v_mfma_f32_16x16x32_bf16 v[88:91], v[40:43], a[176:179], v[88:91]
    ds_read_b128 v[32:35], v14 offset:0
    ds_read_b128 v[36:39], v15 offset:0
    v_mfma_f32_16x16x32_bf16 v[96:99], v[40:43], a[180:183], v[96:99]
    s_xor_b32 s101, s56, 51388416
    buffer_store_dwordx4 v[28:31], v2, s[20:23], s101 offen sc0 sc1
    v_mfma_f32_16x16x32_bf16 v[92:95], v[44:47], a[180:183], v[92:95]
    v_fmac_f32_e64 v64, v76, v4
    v_cvt_pk_bf16_f32 v80, v80, v68
    v_mfma_f32_16x16x32_bf16 v[96:99], v[44:47], a[176:179], v[96:99]
    s_waitcnt lgkmcnt(4)
    v_fmac_f32 v72, v84, v4
    v_cvt_pk_bf16_f32 v112, v64, v72
    v_mfma_f32_16x16x32_bf16 v[88:91], v[48:51], a[240:243], v[88:91]
    ds_read_b128 v[40:43], v14 offset:8192
    ds_read_b128 v[44:47], v15 offset:8192
    v_mfma_f32_16x16x32_bf16 v[96:99], v[48:51], a[244:247], v[96:99]
    v_mov_b32_dpp v114, v80 row_ror:8 row_mask:0xf bank_mask:0xf
    v_mfma_f32_16x16x32_bf16 v[92:95], v[52:55], a[244:247], v[92:95]
    v_sub_f32 v65, v65, v69
    v_sub_f32_e64 v77, v77, v81
    v_mfma_f32_16x16x32_bf16 v[96:99], v[52:55], a[240:243], v[96:99]
    s_waitcnt lgkmcnt(4)
    v_fma_f32 v81, -v77, v4, v65
    v_fma_f32 v69, -v85, v4, v73
    v_mfma_f32_16x16x32_bf16 v[88:91], v[56:59], v[208:211], v[88:91]
    ds_read_b128 v[48:51], v14 offset:16384
    ds_read_b128 v[52:55], v15 offset:16384
    v_mfma_f32_16x16x32_bf16 v[96:99], v[56:59], v[212:215], v[96:99]
    v_fmac_f32_e64 v65, v77, v4
    v_mfma_f32_16x16x32_bf16 v[92:95], v[60:63], v[212:215], v[92:95]
    s_add_u32 m0, s65, 143360
    v_cvt_pk_bf16_f32 v81, v81, v69
    v_fmac_f32 v73, v85, v4
    v_mfma_f32_16x16x32_bf16 v[96:99], v[60:63], v[208:211], v[96:99]
    s_waitcnt lgkmcnt(4)
    v_cvt_pk_bf16_f32 v116, v65, v73
    v_mov_b32_dpp v118, v81 row_ror:8 row_mask:0xf bank_mask:0xf
    v_mfma_f32_16x16x32_bf16 v[100:103], v[32:35], a[88:91], 0
    ds_read_b128 v[56:59], v14 offset:24576
    ds_read_b128 v[60:63], v15 offset:24576
    v_mfma_f32_16x16x32_bf16 v[108:111], v[32:35], a[92:95], 0
    s_add_u32 s60, s48, 49152
    buffer_load_dwordx4 v3, s[32:35], s60 offen lds
    v_mfma_f32_16x16x32_bf16 v[104:107], v[36:39], a[92:95], 0
    v_sub_f32 v66, v66, v70
    v_sub_f32_e64 v78, v78, v82
    v_mfma_f32_16x16x32_bf16 v[108:111], v[36:39], a[88:91], v[108:111]
    s_waitcnt lgkmcnt(4)
    v_fma_f32 v82, -v78, v4, v66
    v_fma_f32 v70, -v86, v4, v74
    v_mfma_f32_16x16x32_bf16 v[100:103], v[40:43], a[184:187], v[100:103]
    s_waitcnt vmcnt(8)
    s_barrier
    ds_read_b128 v[32:35], v8 offset:32768
    ds_read_b128 v[36:39], v9 offset:32768
    v_mfma_f32_16x16x32_bf16 v[108:111], v[40:43], a[188:191], v[108:111]
    v_fmac_f32_e64 v66, v78, v4
    v_mfma_f32_16x16x32_bf16 v[104:107], v[44:47], a[188:191], v[104:107]
    v_cvt_pk_bf16_f32 v82, v82, v70
    v_fmac_f32 v74, v86, v4
    v_mfma_f32_16x16x32_bf16 v[108:111], v[44:47], a[184:187], v[108:111]
    s_waitcnt lgkmcnt(4)
    v_cvt_pk_bf16_f32 v120, v66, v74
    v_mov_b32_dpp v122, v82 row_ror:8 row_mask:0xf bank_mask:0xf
    v_mfma_f32_16x16x32_bf16 v[100:103], v[48:51], a[248:251], v[100:103]
    ds_read_b128 v[40:43], v8 offset:40960
    ds_read_b128 v[44:47], v9 offset:40960
    v_mfma_f32_16x16x32_bf16 v[108:111], v[48:51], a[252:255], v[108:111]
    v_sub_f32_e64 v67, v67, v71
    v_mfma_f32_16x16x32_bf16 v[104:107], v[52:55], a[252:255], v[104:107]
    v_sub_f32 v79, v79, v83
    v_fma_f32 v83, -v79, v4, v67
    v_mfma_f32_16x16x32_bf16 v[108:111], v[52:55], a[248:251], v[108:111]
    s_waitcnt lgkmcnt(4)
    v_fma_f32 v71, -v87, v4, v75
    v_fmac_f32_e64 v67, v79, v4
    v_mfma_f32_16x16x32_bf16 v[100:103], v[56:59], v[216:219], v[100:103]
    ds_read_b128 v[48:51], v8 offset:49152
    ds_read_b128 v[52:55], v9 offset:49152
    v_mfma_f32_16x16x32_bf16 v[108:111], v[56:59], v[220:223], v[108:111]
    v_mfma_f32_16x16x32_bf16 v[104:107], v[60:63], v[220:223], v[104:107]
    s_add_u32 m0, s65, 147456
    v_cvt_pk_bf16_f32 v83, v83, v71
    v_fmac_f32 v75, v87, v4
    v_mfma_f32_16x16x32_bf16 v[108:111], v[60:63], v[216:219], v[108:111]
    s_waitcnt lgkmcnt(4)
    v_cvt_pk_bf16_f32 v124, v67, v75
    v_mov_b32_dpp v126, v83 row_ror:8 row_mask:0xf bank_mask:0xf
    v_mfma_f32_16x16x32_bf16 v[64:67], v[32:35], a[64:67], 0
    ds_read_b128 v[56:59], v8 offset:57344
    ds_read_b128 v[60:63], v9 offset:57344
    v_mfma_f32_16x16x32_bf16 v[72:75], v[32:35], a[68:71], 0
    s_add_u32 s60, s48, 65536
    buffer_load_dwordx4 v3, s[32:35], s60 offen lds
    v_mfma_f32_16x16x32_bf16 v[68:71], v[36:39], a[68:71], 0
    v_sub_f32_e64 v88, v88, v92
    v_sub_f32 v100, v100, v104
    v_mfma_f32_16x16x32_bf16 v[72:75], v[36:39], a[64:67], v[72:75]
    s_waitcnt lgkmcnt(4)
    v_fma_f32 v104, -v100, v4, v88
    v_fma_f32 v92, -v108, v4, v96
    v_mfma_f32_16x16x32_bf16 v[64:67], v[40:43], a[160:163], v[64:67]
    ds_read_b128 v[32:35], v10 offset:32768
    ds_read_b128 v[36:39], v11 offset:32768
    v_mfma_f32_16x16x32_bf16 v[72:75], v[40:43], a[164:167], v[72:75]
    v_fmac_f32 v88, v100, v4
    v_cvt_pk_bf16_f32 v104, v104, v92
    v_mfma_f32_16x16x32_bf16 v[68:71], v[44:47], a[164:167], v[68:71]
    v_fmac_f32 v96, v108, v4
    v_cvt_pk_bf16_f32 v113, v88, v96
    v_mfma_f32_16x16x32_bf16 v[72:75], v[44:47], a[160:163], v[72:75]
    s_waitcnt lgkmcnt(4)
    v_mov_b32_dpp v115, v104 row_ror:8 row_mask:0xf bank_mask:0xf
    v_sub_f32 v89, v89, v93
    v_mfma_f32_16x16x32_bf16 v[64:67], v[48:51], a[224:227], v[64:67]
    ds_read_b128 v[40:43], v10 offset:40960
    ds_read_b128 v[44:47], v11 offset:40960
    v_mfma_f32_16x16x32_bf16 v[72:75], v[48:51], a[228:231], v[72:75]
    v_sub_f32_e64 v101, v101, v105
    v_fma_f32 v105, -v101, v4, v89
    v_mfma_f32_16x16x32_bf16 v[68:71], v[52:55], a[228:231], v[68:71]
    v_fma_f32 v93, -v109, v4, v97
    v_fmac_f32_e64 v89, v101, v4
    v_mfma_f32_16x16x32_bf16 v[72:75], v[52:55], a[224:227], v[72:75]
    s_waitcnt lgkmcnt(4)
    v_cvt_pk_bf16_f32 v105, v105, v93
    v_fmac_f32 v97, v109, v4
    v_mfma_f32_16x16x32_bf16 v[64:67], v[56:59], v[192:195], v[64:67]
    ds_read_b128 v[48:51], v10 offset:49152
    ds_read_b128 v[52:55], v11 offset:49152
    v_mfma_f32_16x16x32_bf16 v[72:75], v[56:59], v[196:199], v[72:75]
    s_xor_b32 s101, s56, 35659776
    buffer_store_dwordx4 v[112:115], v2, s[20:23], s101 offen sc0 sc1
    v_mfma_f32_16x16x32_bf16 v[68:71], v[60:63], v[196:199], v[68:71]
    s_add_u32 m0, s65, 151552
    v_cvt_pk_bf16_f32 v117, v89, v97
    v_mov_b32_dpp v119, v105 row_ror:8 row_mask:0xf bank_mask:0xf
    v_mfma_f32_16x16x32_bf16 v[72:75], v[60:63], v[192:195], v[72:75]
    s_waitcnt lgkmcnt(4)
    v_sub_f32 v90, v90, v94
    v_sub_f32_e64 v102, v102, v106
    v_mfma_f32_16x16x32_bf16 v[76:79], v[32:35], a[72:75], 0
    ds_read_b128 v[56:59], v10 offset:57344
    ds_read_b128 v[60:63], v11 offset:57344
    v_mfma_f32_16x16x32_bf16 v[84:87], v[32:35], a[76:79], 0
    s_waitcnt vmcnt(3)
    s_barrier
    s_cmp_lg_u32 s40, 0
    s_cbranch_scc1 Larr1
    s_add_u32 s52, s61, 49664
    v_mov_b32_e64 v7, 1
    s_mov_b64 exec, 1
    buffer_atomic_add v7, off, s[20:23], s52 sc0 sc1
    s_mov_b64 exec, -1
Larr1:
    s_add_u32 s60, s48, 81920
    buffer_load_dwordx4 v3, s[32:35], s60 offen lds
    v_mfma_f32_16x16x32_bf16 v[80:83], v[36:39], a[76:79], 0
    v_fma_f32 v106, -v102, v4, v90
    v_fma_f32 v94, -v110, v4, v98
    v_mfma_f32_16x16x32_bf16 v[84:87], v[36:39], a[72:75], v[84:87]
    s_waitcnt lgkmcnt(4)
    v_fmac_f32 v90, v102, v4
    v_cvt_pk_bf16_f32 v106, v106, v94
    v_mfma_f32_16x16x32_bf16 v[76:79], v[40:43], a[168:171], v[76:79]
    ds_read_b128 v[32:35], v12 offset:32768
    ds_read_b128 v[36:39], v13 offset:32768
    v_mfma_f32_16x16x32_bf16 v[84:87], v[40:43], a[172:175], v[84:87]
    s_xor_b32 s101, s56, 35663872
    buffer_store_dwordx4 v[116:119], v2, s[20:23], s101 offen sc0 sc1
    v_mfma_f32_16x16x32_bf16 v[80:83], v[44:47], a[172:175], v[80:83]
    v_fmac_f32 v98, v110, v4
    v_cvt_pk_bf16_f32 v121, v90, v98
    v_mfma_f32_16x16x32_bf16 v[84:87], v[44:47], a[168:171], v[84:87]
    s_waitcnt lgkmcnt(4)
    v_mov_b32_dpp v123, v106 row_ror:8 row_mask:0xf bank_mask:0xf
    v_sub_f32_e64 v91, v91, v95
    v_mfma_f32_16x16x32_bf16 v[76:79], v[48:51], a[232:235], v[76:79]
    ds_read_b128 v[40:43], v12 offset:40960
    ds_read_b128 v[44:47], v13 offset:40960
    v_mfma_f32_16x16x32_bf16 v[84:87], v[48:51], a[236:239], v[84:87]
    v_sub_f32_e64 v103, v103, v107
    v_mfma_f32_16x16x32_bf16 v[80:83], v[52:55], a[236:239], v[80:83]
    v_fma_f32 v107, -v103, v4, v91
    v_fma_f32 v95, -v111, v4, v99
    v_mfma_f32_16x16x32_bf16 v[84:87], v[52:55], a[232:235], v[84:87]
    s_waitcnt lgkmcnt(4)
    v_fmac_f32 v91, v103, v4
    v_cvt_pk_bf16_f32 v107, v107, v95
    v_mfma_f32_16x16x32_bf16 v[76:79], v[56:59], v[200:203], v[76:79]
    ds_read_b128 v[48:51], v12 offset:49152
    ds_read_b128 v[52:55], v13 offset:49152
    v_mfma_f32_16x16x32_bf16 v[84:87], v[56:59], v[204:207], v[84:87]
    s_xor_b32 s101, s56, 35651584
    buffer_store_dwordx4 v[120:123], v2, s[20:23], s101 offen sc0 sc1
    v_mfma_f32_16x16x32_bf16 v[80:83], v[60:63], v[204:207], v[80:83]
    s_add_u32 m0, s65, 155648
    v_fmac_f32 v99, v111, v4
    v_cvt_pk_bf16_f32 v125, v91, v99
    v_mfma_f32_16x16x32_bf16 v[84:87], v[60:63], v[200:203], v[84:87]
    s_waitcnt lgkmcnt(4)
    v_mov_b32_dpp v127, v107 row_ror:8 row_mask:0xf bank_mask:0xf
    v_mfma_f32_16x16x32_bf16 v[88:91], v[32:35], a[80:83], 0
    ds_read_b128 v[56:59], v12 offset:57344
    ds_read_b128 v[60:63], v13 offset:57344
    v_mfma_f32_16x16x32_bf16 v[96:99], v[32:35], a[84:87], 0
    s_add_u32 s60, s48, 98304
    buffer_load_dwordx4 v3, s[32:35], s60 offen lds
    v_mfma_f32_16x16x32_bf16 v[92:95], v[36:39], a[84:87], 0
    v_sub_f32 v64, v64, v68
    v_sub_f32_e64 v76, v76, v80
    v_mfma_f32_16x16x32_bf16 v[96:99], v[36:39], a[80:83], v[96:99]
    s_waitcnt lgkmcnt(4)
    v_fma_f32 v80, -v76, v4, v64
    v_fma_f32 v68, -v84, v4, v72
    v_mfma_f32_16x16x32_bf16 v[88:91], v[40:43], a[176:179], v[88:91]
    ds_read_b128 v[32:35], v14 offset:32768
    ds_read_b128 v[36:39], v15 offset:32768
    v_mfma_f32_16x16x32_bf16 v[96:99], v[40:43], a[180:183], v[96:99]
    s_xor_b32 s101, s56, 35655680
    buffer_store_dwordx4 v[124:127], v2, s[20:23], s101 offen sc0 sc1
    v_mfma_f32_16x16x32_bf16 v[92:95], v[44:47], a[180:183], v[92:95]
    v_fmac_f32_e64 v64, v76, v4
    v_cvt_pk_bf16_f32 v80, v80, v68
    v_mfma_f32_16x16x32_bf16 v[96:99], v[44:47], a[176:179], v[96:99]
    s_waitcnt lgkmcnt(4)
    v_fmac_f32 v72, v84, v4
    v_cvt_pk_bf16_f32 v16, v64, v72
    v_mfma_f32_16x16x32_bf16 v[88:91], v[48:51], a[240:243], v[88:91]
    ds_read_b128 v[40:43], v14 offset:40960
    ds_read_b128 v[44:47], v15 offset:40960
    v_mfma_f32_16x16x32_bf16 v[96:99], v[48:51], a[244:247], v[96:99]
    v_mov_b32_dpp v18, v80 row_ror:8 row_mask:0xf bank_mask:0xf
    v_mfma_f32_16x16x32_bf16 v[92:95], v[52:55], a[244:247], v[92:95]
    v_sub_f32_e64 v65, v65, v69
    v_sub_f32 v77, v77, v81
    v_mfma_f32_16x16x32_bf16 v[96:99], v[52:55], a[240:243], v[96:99]
    s_waitcnt lgkmcnt(4)
    v_fma_f32 v81, -v77, v4, v65
    v_fma_f32 v69, -v85, v4, v73
    v_mfma_f32_16x16x32_bf16 v[88:91], v[56:59], v[208:211], v[88:91]
    ds_read_b128 v[48:51], v14 offset:49152
    ds_read_b128 v[52:55], v15 offset:49152
    v_mfma_f32_16x16x32_bf16 v[96:99], v[56:59], v[212:215], v[96:99]
    v_fmac_f32_e64 v65, v77, v4
    v_mfma_f32_16x16x32_bf16 v[92:95], v[60:63], v[212:215], v[92:95]
    s_add_u32 m0, s65, 159744
    v_cvt_pk_bf16_f32 v81, v81, v69
    v_fmac_f32 v73, v85, v4
    v_mfma_f32_16x16x32_bf16 v[96:99], v[60:63], v[208:211], v[96:99]
    s_waitcnt lgkmcnt(4)
    v_cvt_pk_bf16_f32 v20, v65, v73
    v_mov_b32_dpp v22, v81 row_ror:8 row_mask:0xf bank_mask:0xf
    v_mfma_f32_16x16x32_bf16 v[100:103], v[32:35], a[88:91], 0
    ds_read_b128 v[56:59], v14 offset:57344
    ds_read_b128 v[60:63], v15 offset:57344
    v_mfma_f32_16x16x32_bf16 v[108:111], v[32:35], a[92:95], 0
    s_add_u32 s60, s48, 114688
    buffer_load_dwordx4 v3, s[32:35], s60 offen lds
    v_mfma_f32_16x16x32_bf16 v[104:107], v[36:39], a[92:95], 0
    v_sub_f32_e64 v66, v66, v70
    v_sub_f32 v78, v78, v82
    v_mfma_f32_16x16x32_bf16 v[108:111], v[36:39], a[88:91], v[108:111]
    s_waitcnt lgkmcnt(4)
    v_fma_f32 v82, -v78, v4, v66
    v_fma_f32 v70, -v86, v4, v74
    v_mfma_f32_16x16x32_bf16 v[100:103], v[40:43], a[184:187], v[100:103]
    v_mfma_f32_16x16x32_bf16 v[108:111], v[40:43], a[188:191], v[108:111]
    v_fmac_f32_e64 v66, v78, v4
    v_mfma_f32_16x16x32_bf16 v[104:107], v[44:47], a[188:191], v[104:107]
    v_cvt_pk_bf16_f32 v82, v82, v70
    v_fmac_f32 v74, v86, v4
    v_mfma_f32_16x16x32_bf16 v[108:111], v[44:47], a[184:187], v[108:111]
    s_waitcnt lgkmcnt(2)
    v_cvt_pk_bf16_f32 v24, v66, v74
    v_mov_b32_dpp v26, v82 row_ror:8 row_mask:0xf bank_mask:0xf
    v_mfma_f32_16x16x32_bf16 v[100:103], v[48:51], a[248:251], v[100:103]
    v_mfma_f32_16x16x32_bf16 v[108:111], v[48:51], a[252:255], v[108:111]
    s_cmp_lg_u32 s40, 0
    s_cbranch_scc1 Lrel1
    s_waitcnt vmcnt(6)
    ds_write_b32 v6, v7 offset:61440
    v_readfirstlane_b32 s52, v7
    v_mov_b32_e64 v7, 64
    s_cmp_lg_u32 s52, 63
    s_cbranch_scc1 Lrel1
    s_add_u32 s52, s61, 16384
    s_mov_b64 exec, 0xff
    buffer_atomic_add v7, v5, s[20:23], s52 offen sc1
    s_mov_b64 exec, -1
Lrel1:
    v_sub_f32 v67, v67, v71
    v_mfma_f32_16x16x32_bf16 v[104:107], v[52:55], a[252:255], v[104:107]
    v_sub_f32 v79, v79, v83
    v_fma_f32 v83, -v79, v4, v67
    v_mfma_f32_16x16x32_bf16 v[108:111], v[52:55], a[248:251], v[108:111]
    s_waitcnt lgkmcnt(0)
    v_fma_f32 v71, -v87, v4, v75
    v_fmac_f32_e64 v67, v79, v4
    v_mfma_f32_16x16x32_bf16 v[100:103], v[56:59], v[216:219], v[100:103]
    v_mfma_f32_16x16x32_bf16 v[108:111], v[56:59], v[220:223], v[108:111]
    v_mfma_f32_16x16x32_bf16 v[104:107], v[60:63], v[220:223], v[104:107]
    v_cvt_pk_bf16_f32 v83, v83, v71
    v_fmac_f32_e64 v75, v87, v4
    v_mfma_f32_16x16x32_bf16 v[108:111], v[60:63], v[216:219], v[108:111]
    v_cvt_pk_bf16_f32 v28, v67, v75
    v_mov_b32_dpp v30, v83 row_ror:8 row_mask:0xf bank_mask:0xf
    v_and_b32_e64 v8, 3, v1
    v_lshlrev_b32 v8, 9, v8
    s_waitcnt lgkmcnt(0)
    s_barrier
    ds_read_b32 v9, v6 offset:61440
    s_nop 2
    v_sub_f32 v88, v88, v92
    v_sub_f32 v100, v100, v104
    v_fma_f32 v104, -v100, v4, v88
    v_fma_f32 v92, -v108, v4, v96
    v_fmac_f32 v88, v100, v4
    v_cvt_pk_bf16_f32 v104, v104, v92
    v_fmac_f32 v96, v108, v4
    v_cvt_pk_bf16_f32 v17, v88, v96
    v_mov_b32_dpp v19, v104 row_ror:8 row_mask:0xf bank_mask:0xf
    s_xor_b32 s101, s56, 52436992
    buffer_store_dwordx4 v[16:19], v2, s[20:23], s101 offen sc0 sc1
    v_sub_f32 v89, v89, v93
    v_sub_f32 v101, v101, v105
    v_fma_f32 v105, -v101, v4, v89
    v_fma_f32 v93, -v109, v4, v97
    v_fmac_f32 v89, v101, v4
    v_cvt_pk_bf16_f32 v105, v105, v93
    v_fmac_f32 v97, v109, v4
    v_cvt_pk_bf16_f32 v21, v89, v97
    v_mov_b32_dpp v23, v105 row_ror:8 row_mask:0xf bank_mask:0xf
    s_xor_b32 s101, s56, 52441088
    buffer_store_dwordx4 v[20:23], v2, s[20:23], s101 offen sc0 sc1
    v_sub_f32 v90, v90, v94
    v_sub_f32 v102, v102, v106
    v_fma_f32 v106, -v102, v4, v90
    v_fma_f32 v94, -v110, v4, v98
    v_fmac_f32_e64 v90, v102, v4
    v_cvt_pk_bf16_f32 v106, v106, v94
    v_fmac_f32_e64 v98, v110, v4
    v_cvt_pk_bf16_f32 v25, v90, v98
    v_mov_b32_dpp v27, v106 row_ror:8 row_mask:0xf bank_mask:0xf
    s_xor_b32 s101, s56, 52428800
    buffer_store_dwordx4 v[24:27], v2, s[20:23], s101 offen sc0 sc1
    v_sub_f32 v91, v91, v95
    v_sub_f32 v103, v103, v107
    v_fma_f32 v107, -v103, v4, v91
    v_fma_f32 v95, -v111, v4, v99
    v_fmac_f32 v91, v103, v4
    v_cvt_pk_bf16_f32 v107, v107, v95
    v_fmac_f32_e64 v99, v111, v4
    v_cvt_pk_bf16_f32 v29, v91, v99
    v_mov_b32_dpp v31, v107 row_ror:8 row_mask:0xf bank_mask:0xf
    s_xor_b32 s101, s56, 52432896
    buffer_store_dwordx4 v[28:31], v2, s[20:23], s101 offen sc0 sc1
    s_mov_b32 s46, s45
    s_waitcnt lgkmcnt(0)
    v_readfirstlane_b32 s93, v9
    s_add_u32 m0, s65, 0
    s_add_u32 s100, s49, 0
    buffer_load_dwordx4 v3, s[32:35], s100 offen lds
    s_add_u32 m0, s65, 4096
    s_add_u32 s100, s49, 16384
    buffer_load_dwordx4 v3, s[32:35], s100 offen lds
    s_add_u32 m0, s65, 8192
    s_add_u32 s100, s49, 32768
    buffer_load_dwordx4 v3, s[32:35], s100 offen lds
    s_add_u32 m0, s65, 12288
    s_add_u32 s100, s49, 49152
    buffer_load_dwordx4 v3, s[32:35], s100 offen lds
    s_lshr_b32 s52, s42, 2
    s_lshl_b32 s52, s52, 3
    s_add_u32 s52, s52, s41
    s_lshr_b32 s43, s52, 1
    s_and_b32 s44, s52, 1
    s_lshr_b32 s66, s43, 2
    s_lshl_b32 s66, s66, 22
    s_lshl_b32 s53, s44, 15
    s_add_u32 s66, s66, s53
    s_and_b32 s53, s43, 3
    s_lshl_b32 s53, s53, 12
    s_add_u32 s66, s66, s53
    s_and_b32 s53, s52, 3
    s_lshr_b32 s47, s52, 3
    s_lshl_b32 s47, s47, 2
    s_add_u32 s47, s47, s53
    s_and_b32 s54, s47, 16
    s_add_u32 s54, s54, s47
    s_lshl_b32 s54, s54, 9
    s_lshl_b32 s47, s47, 16
    s_and_b32 s53, s52, 4
    s_lshl_b32 s53, s53, 11
    s_xor_b32 s53, s53, s92
    s_add_u32 s47, s47, s53
    s_add_u32 s54, s54, s53
    s_xor_b32 s54, s54, 31596544
    s_lshl_b32 s53, s40, 11
    s_add_u32 s47, s47, s53
    s_add_u32 s47, s47, 29360128
    s_lshr_b32 s53, s40, 1
    s_lshl_b32 s52, s46, 1
    s_add_u32 s53, s53, s52
    s_lshl_b32 s53, s53, 16
    s_add_u32 s66, s66, s53
    s_and_b32 s53, s40, 1
    s_lshl_b32 s53, s53, 8
    s_add_u32 s66, s66, s53
    s_lshl_b32 s53, s40, 12
    s_and_b32 s53, s53, s94
    s_or_b32 s53, s53, s95
    s_xor_b32 s66, s66, s53
    v_mov_b32 v58, v8
    v_mov_b32 v59, v5
    v_and_b32 v44, 31, v1
    v_lshrrev_b32_e64 v45, 5, v1
    v_bfe_u32 v48, v1, 4, 1
    v_lshlrev_b32 v26, 19, v48
    v_and_b32 v48, 15, v1
    v_lshl_add_u32 v26, v48, 4, v26
    v_lshl_add_u32 v26, v45, 9, v26
    s_add_u32 s52, s44, 32
    v_lshl_add_u32 v46, v44, 1, s52
    v_mul_u32_u24 v47, v45, v46
    v_cvt_f32_u32 v46, v46
    v_cvt_f32_u32 v47, v47
    v_mul_f32 v47, 0x3e000000, v47
    s_mov_b32 s68, 0xbcf6384f
    s_mov_b32 s69, 0x7fffffff
    v_mov_b32 v40, 0xbfb17218
    v_mov_b32 v41, 0xbfb17218
    v_mov_b32 v28, 1.0
    v_mov_b32 v29, 1.0
    v_lshlrev_b32 v30, 6, v58
    v_lshlrev_b32 v31, 2, v44
    v_fmamk_f32 v48, v46, 0x3baaaaab, v47
    v_cos_f32 v49, v48
    v_sin_f32 v48, v48
    v_mul_f32 v49, s68, v49
    v_mul_f32 v48, -v48, s68
    v_cvt_pk_bf16_f32 v8, v49, v48
    v_mov_b32 v12, v8
    v_fmamk_f32 v48, v46, 0x3cd55555, v47
    v_cos_f32 v49, v48
    v_sin_f32 v48, v48
    v_mul_f32_e64 v49, s68, v49
    v_mul_f32 v48, -v48, s68
    v_cvt_pk_bf16_f32 v9, v49, v48
    v_mov_b32 v13, v9
    s_cmp_lg_u32 s40, 1
    s_cbranch_scc1 Lsmpa
    s_add_u32 s59, s3, 0
    buffer_load_dword v61, off, s[20:23], s59 sc1
    s_add_u32 s59, s3, 16384
    buffer_load_dword v43, off, s[20:23], s59 sc1
Lsmpa:
    v_fmamk_f32 v48, v46, 0x3e82aaab, v47
    v_cos_f32 v49, v48
    v_sin_f32 v48, v48
    v_mul_f32_e64 v49, s68, v49
    v_mul_f32 v48, -v48, s68
    v_cvt_pk_bf16_f32 v10, v49, v48
    v_fmamk_f32 v48, v46, 0x3e8d5555, v47
    v_cos_f32 v49, v48
    v_sin_f32 v48, v48
    v_mul_f32_e64 v49, s68, v49
    v_mul_f32 v48, -v48, s68
    v_cvt_pk_bf16_f32 v11, v49, v48
    v_fmamk_f32 v48, v46, 0x3d400000, v47
    v_cos_f32_e64 v49, v48
    v_sin_f32 v48, v48
    v_mul_f32 v49, s68, v49
    v_mul_f32 v48, -v48, s68
    v_cvt_pk_bf16_f32 v14, v49, v48
    v_mov_b32 v18, v14
    v_fmamk_f32 v48, v46, 0x3d8aaaab, v47
    v_cos_f32 v49, v48
    v_sin_f32 v48, v48
    v_mul_f32 v49, s68, v49
    v_mul_f32 v48, -v48, s68
    v_cvt_pk_bf16_f32 v15, v49, v48
    v_mov_b32 v19, v15
    v_fmamk_f32 v48, v46, 0x3e980000, v47
    v_cos_f32 v49, v48
    v_sin_f32 v48, v48
    v_mul_f32 v49, s68, v49
    v_mul_f32 v48, -v48, s68
    v_cvt_pk_bf16_f32 v16, v49, v48
    v_fmamk_f32 v48, v46, 0x3ea2aaab, v47
    v_cos_f32 v49, v48
    v_sin_f32 v48, v48
    v_mul_f32 v49, s68, v49
    v_mul_f32 v48, -v48, s68
    v_cvt_pk_bf16_f32 v17, v49, v48
    v_fmamk_f32 v48, v46, 0x3db55555, v47
    v_cos_f32 v49, v48
Lpg6:
    s_cbranch_execz Lback
    v_sin_f32 v48, v48
    v_mul_f32 v49, s68, v49
    v_mul_f32 v48, -v48, s68
    v_cvt_pk_bf16_f32 v20, v49, v48
    v_mov_b32 v24, v20
    v_fmamk_f32 v48, v46, 0x3de00000, v47
    v_cos_f32 v49, v48
    v_sin_f32 v48, v48
    v_mul_f32_e64 v49, s68, v49
    v_mul_f32 v48, -v48, s68
    v_cvt_pk_bf16_f32 v21, v49, v48
    v_mov_b32 v25, v21
    v_fmamk_f32 v48, v46, 0x3ead5555, v47
    v_cos_f32 v49, v48
    v_sin_f32 v48, v48
    v_mul_f32 v49, s68, v49
    v_mul_f32 v48, -v48, s68
    v_cvt_pk_bf16_f32 v22, v49, v48
    v_fmamk_f32 v48, v46, 0x3eb80000, v47
    v_cos_f32 v49, v48
    v_sin_f32 v48, v48
    v_mul_f32 v49, s68, v49
    v_mul_f32 v48, -v48, s68
    v_cvt_pk_bf16_f32 v23, v49, v48
    s_waitcnt vmcnt(4)
    s_barrier
    s_cmp_lg_u32 s40, 0
    s_cbranch_scc1 Larr2
    s_add_u32 s52, s61, 50176
    v_mov_b32 v60, 1
    s_mov_b64 exec, 1
    buffer_atomic_add v60, off, s[20:23], s52 sc0 sc1
    s_mov_b64 exec, -1
Larr2:
    s_cmp_lg_u32 s40, 1
    s_cbranch_scc1 Lgo0
    s_waitcnt vmcnt(0)
    s_mov_b32 s53, 0
Lchk0:
    v_cmp_gt_u32 vcc, 64, v61
    s_add_u32 s53, s53, 1
    s_cmp_ge_u32 s53, 0x200000
    s_cbranch_scc1 Lgo0
    s_nop 1
    s_cbranch_vccz Lgo0
    s_add_u32 s59, s3, 0
    buffer_load_dword v61, off, s[20:23], s59 sc1
    s_waitcnt vmcnt(0)
    s_branch Lchk0
Lgo0:
    s_barrier
    s_cmp_lg_u32 s40, 0
    s_cbranch_scc1 Lrel2
    s_waitcnt vmcnt(0)
    v_readfirstlane_b32 s52, v60
    v_mov_b32_e64 v60, 64
    s_cmp_lg_u32 s52, 63
    s_cbranch_scc1 Lrel2
    s_add_u32 s52, s61, 32768
    s_mov_b64 exec, 0xff
    buffer_atomic_add v60, v59, s[20:23], s52 offen sc1
    s_mov_b64 exec, -1
Lrel2:
    s_xor_b32 s60, s66, 33554432
    buffer_load_dwordx4 a[0:3], v26, s[20:23], s60 offen offset:0 sc1
    buffer_load_dwordx4 a[4:7], v26, s[20:23], s60 offen offset:1024 sc1
    buffer_load_dwordx4 a[8:11], v26, s[20:23], s60 offen offset:2048 sc1
    buffer_load_dwordx4 a[12:15], v26, s[20:23], s60 offen offset:3072 sc1
    s_lshr_b32 s52, s43, 4
    s_mul_i32 s52, s52, 1024000
    s_add_u32 s36, s10, s52
    s_addc_u32 s37, s11, 0
    s_mov_b32 s38, 1024000
    s_mov_b32 s39, 0x20000
    s_and_b32 s52, s43, 7
    s_lshl_b32 s52, s52, 7
    s_bfe_u32 s53, s43, 0x10003
    s_add_u32 s52, s52, s53
    s_lshl_b32 s53, s44, 1
    s_add_u32 s52, s52, s53
    s_lshl_b32 s53, s40, 5
    s_add_u32 s52, s52, s53
    s_lshl_b32 s52, s52, 10
    s_and_b32 s53, s64, 0x300
    s_add_u32 s52, s52, s53
    v_lshrrev_b32 v48, 4, v1
    v_and_b32 v49, 15, v1
    v_lshlrev_b32 v7, 12, v48
    v_lshl_add_u32 v7, v49, 4, v7
    v_add_u32 v7, s52, v7
    v_add_u32 v2, 0x4000, v7
    v_xor_b32 v49, v48, v49
    v_lshlrev_b32 v56, 8, v48
    v_lshl_add_u32 v56, v49, 4, v56
    s_lshl_b32 s52, s40, 11
    v_add_u32 v56, s52, v56
    v_xor_b32 v57, 64, v56
    s_lshl_b32 s52, s40, 2
    v_lshl_add_u32 v48, v45, 1, s52
    v_and_b32 v49, 7, v1
    v_xor_b32 v48, v48, v49
    v_lshlrev_b32 v54, 8, v44
    v_lshl_add_u32 v54, v48, 4, v54
    v_xor_b32 v55, 16, v54
    v_add_u32 v53, 98304, v6
    s_lshl_b32 s52, s40, 11
    v_add_u32 v52, s52, v53
    v_bfe_u32 v48, v1, 2, 2
    v_xor_b32_e64 v49, s40, v48
    v_lshl_add_u32 v48, v45, 2, v48
    s_lshl_b32 s52, s44, 3
    v_add_lshl_u32 v4, v48, s52, 8
    v_lshl_add_u32 v4, v49, 6, v4
    v_and_b32 v48, 1, v1
    v_lshl_add_u32 v4, v48, 5, v4
    v_bfe_u32 v48, v1, 1, 1
    v_lshl_add_u32 v4, v48, 3, v4
    v_bfe_u32 v48, v1, 4, 1
    v_lshl_add_u32 v4, v48, 4, v4
    v_add_u32 v5, 0x10000, v4
    v_add_u32 v62, 0x20000, v4
    v_xor_b32 v50, 0x800, v4
    v_xor_b32 v51, 0x800, v5
    v_xor_b32 v63, 0x800, v62
    s_cmp_ge_u32 s93, 44
    s_cbranch_scc1 Lth4
    s_waitcnt vmcnt(3)
Lth4:
    s_cmp_lg_u32 s40, 1
    s_cbranch_scc1 Lsmp1
    s_add_u32 s59, s3, 16384
    buffer_load_dword v61, off, s[20:23], s59 sc1
Lsmp1:
    s_xor_b32 s60, s66, 33570816
    buffer_load_dwordx4 a[16:19], v26, s[20:23], s60 offen offset:0 sc1
    s_add_u32 m0, s65, 16384
    s_add_u32 s100, s49, 65536
    buffer_load_dwordx4 v3, s[32:35], s100 offen lds
    s_cmp_ge_u32 s93, 44
    s_cbranch_scc1 Lth5
    s_waitcnt vmcnt(4)
Lth5:
    buffer_load_dwordx4 a[20:23], v26, s[20:23], s60 offen offset:1024 sc1
    s_add_u32 m0, s65, 20480
    s_add_u32 s100, s49, 81920
    buffer_load_dwordx4 v3, s[32:35], s100 offen lds
    s_cmp_ge_u32 s93, 44
    s_cbranch_scc1 Lth6
    s_waitcnt vmcnt(5)
Lth6:
    buffer_load_dwordx4 a[24:27], v26, s[20:23], s60 offen offset:2048 sc1
    s_add_u32 m0, s65, 24576
    s_add_u32 s100, s49, 98304
    buffer_load_dwordx4 v3, s[32:35], s100 offen lds
    s_cmp_ge_u32 s93, 44
    s_cbranch_scc1 Lth7
    s_waitcnt vmcnt(6)
Lth7:
    buffer_load_dwordx4 a[28:31], v26, s[20:23], s60 offen offset:3072 sc1
    s_add_u32 m0, s65, 28672
    s_add_u32 s100, s49, 114688
    buffer_load_dwordx4 v3, s[32:35], s100 offen lds
    s_add_u32 m0, s65, 32768
    s_add_u32 s100, s50, 0
    buffer_load_dwordx4 v3, s[32:35], s100 offen lds
    s_cmp_ge_u32 s93, 44
    s_cbranch_scc1 Lth8
    s_waitcnt vmcnt(8)
Lth8:
    s_cmp_lg_u32 s40, 1
    s_cbranch_scc1 Lgo1
    s_waitcnt vmcnt(13)
    v_cmp_gt_u32 vcc, 64, v43
    s_nop 4
    s_cbranch_vccz Lgo1
    s_waitcnt vmcnt(9)
    s_mov_b32 s53, 0
Lchk1:
    v_cmp_gt_u32 vcc, 64, v61
    s_add_u32 s53, s53, 1
    s_cmp_ge_u32 s53, 0x200000
    s_cbranch_scc1 Lgo1
    s_nop 1
    s_cbranch_vccz Lgo1
    s_add_u32 s59, s3, 16384
    buffer_load_dword v61, off, s[20:23], s59 sc1
    s_waitcnt vmcnt(0)
    s_branch Lchk1
Lgo1:
    s_barrier
    s_xor_b32 s60, s66, 34607104
    buffer_load_dwordx4 a[36:39], v26, s[20:23], s60 offen offset:0 sc1
    s_add_u32 m0, s65, 36864
    s_add_u32 s100, s50, 16384
    buffer_load_dwordx4 v3, s[32:35], s100 offen lds
    s_cmp_ge_u32 s93, 44
    s_cbranch_scc1 Lth9
    s_waitcnt vmcnt(8)
Lth9:
    buffer_load_dwordx4 a[40:43], v26, s[20:23], s60 offen offset:1024 sc1
    s_add_u32 m0, s65, 40960
    s_add_u32 s100, s50, 32768
    buffer_load_dwordx4 v3, s[32:35], s100 offen lds
    s_cmp_ge_u32 s93, 44
    s_cbranch_scc1 Lth10
    s_waitcnt vmcnt(8)
Lth10:
    buffer_load_dwordx4 a[44:47], v26, s[20:23], s60 offen offset:2048 sc1
    s_add_u32 m0, s65, 45056
    s_add_u32 s100, s50, 49152
    buffer_load_dwordx4 v3, s[32:35], s100 offen lds
    s_cmp_ge_u32 s93, 44
    s_cbranch_scc1 Lth11
    s_waitcnt vmcnt(8)
Lth11:
    buffer_load_dwordx4 a[48:51], v26, s[20:23], s60 offen offset:3072 sc1
    s_add_u32 m0, s65, 49152
    s_add_u32 s100, s50, 65536
    buffer_load_dwordx4 v3, s[32:35], s100 offen lds
    s_add_u32 m0, s65, 53248
    s_add_u32 s100, s50, 81920
    buffer_load_dwordx4 v3, s[32:35], s100 offen lds
    s_cmp_ge_u32 s93, 44
    s_cbranch_scc1 Lth12
    s_waitcnt vmcnt(8)
Lth12:
    s_cmp_lg_u32 s40, 1
    s_cbranch_scc1 Lsmp2
    s_add_u32 s59, s3, 32768
    buffer_load_dword v61, off, s[20:23], s59 sc1
Lsmp2:
    s_xor_b32 s60, s66, 34623488
    buffer_load_dwordx4 a[52:55], v26, s[20:23], s60 offen offset:0 sc1
    s_cmp_ge_u32 s93, 44
    s_cbranch_scc1 Lth13
    s_waitcnt vmcnt(7)
Lth13:
    buffer_load_dwordx4 a[56:59], v26, s[20:23], s60 offen offset:1024 sc1
    s_cmp_ge_u32 s93, 44
    s_cbranch_scc1 Lth14
    s_waitcnt vmcnt(6)
Lth14:
    buffer_load_dwordx4 a[60:63], v26, s[20:23], s60 offen offset:2048 sc1
    s_cmp_ge_u32 s93, 44
    s_cbranch_scc1 Lth15
    s_waitcnt vmcnt(5)
Lth15:
    buffer_load_dwordx4 a[64:67], v26, s[20:23], s60 offen offset:3072 sc1
    s_cmp_ge_u32 s93, 44
    s_cbranch_scc1 Lth16
    s_waitcnt vmcnt(3)
Lth16:
    s_waitcnt vmcnt(25)
    v_accvgpr_mov_b32 a32, a0
    v_accvgpr_mov_b32 a33, a1
    s_waitcnt vmcnt(24)
    v_mfma_f32_32x32x16_bf16 v[80:95], a[2:5], v[8:11], 0
    s_waitcnt vmcnt(23)
    v_mfma_f32_32x32x16_bf16 v[64:79], a[6:9], v[10:13], 0
    s_waitcnt vmcnt(22)
    v_mfma_f32_32x32x16_bf16 v[80:95], a[10:13], v[8:11], v[80:95]
    s_waitcnt vmcnt(21)
    v_mfma_f32_32x32x16_bf16 v[64:79], a[14:17], v[10:13], v[64:79]
    s_waitcnt vmcnt(19)
    v_mfma_f32_32x32x16_bf16 v[80:95], a[18:21], v[8:11], v[80:95]
    s_waitcnt vmcnt(17)
    v_mfma_f32_32x32x16_bf16 v[64:79], a[22:25], v[10:13], v[64:79]
    s_waitcnt vmcnt(15)
    v_mfma_f32_32x32x16_bf16 v[80:95], a[26:29], v[8:11], v[80:95]
    v_mfma_f32_32x32x16_bf16 v[64:79], a[30:33], v[10:13], v[64:79]
    s_waitcnt vmcnt(4)
    s_cmp_lg_u32 s40, 1
    s_cbranch_scc1 Lgo2
    s_waitcnt vmcnt(4)
    s_mov_b32 s53, 0
Lchk2:
    v_cmp_gt_u32 vcc, 64, v61
    s_add_u32 s53, s53, 1
    s_cmp_ge_u32 s53, 0x200000
    s_cbranch_scc1 Lgo2
    s_nop 1
    s_cbranch_vccz Lgo2
    s_add_u32 s59, s3, 32768
    buffer_load_dword v61, off, s[20:23], s59 sc1
    s_waitcnt vmcnt(0)
    s_branch Lchk2
Lgo2:
    s_barrier
    s_xor_b32 s60, s66, 35659776
    buffer_load_dwordx4 a[72:75], v26, s[20:23], s60 offen offset:0 sc1
    s_cmp_ge_u32 s93, 44
    s_cbranch_scc1 Lth17
    s_waitcnt vmcnt(3)
Lth17:
    buffer_load_dwordx4 a[76:79], v26, s[20:23], s60 offen offset:1024 sc1
    s_cmp_ge_u32 s93, 44
    s_cbranch_scc1 Lth18
    s_waitcnt vmcnt(3)
Lth18:
    buffer_load_dwordx4 a[80:83], v26, s[20:23], s60 offen offset:2048 sc1
    s_cmp_ge_u32 s93, 44
    s_cbranch_scc1 Lth19
    s_waitcnt vmcnt(3)
Lth19:
    ds_read_b64_tr_b16 a[108:109], v62 offset:0
    ds_read_b64_tr_b16 a[110:111], v63 offset:0
    ds_read_b64_tr_b16 a[112:113], v62 offset:4096
    ds_read_b64_tr_b16 a[114:115], v63 offset:4096
    ds_read_b64_tr_b16 a[116:117], v62 offset:8192
    ds_read_b64_tr_b16 a[118:119], v63 offset:8192
    ds_read_b64_tr_b16 a[120:121], v62 offset:12288
    ds_read_b64_tr_b16 a[122:123], v63 offset:12288
    ds_read_b64_tr_b16 a[124:125], v62 offset:16384
    ds_read_b64_tr_b16 a[126:127], v63 offset:16384
    ds_read_b64_tr_b16 a[128:129], v62 offset:20480
    ds_read_b64_tr_b16 a[130:131], v63 offset:20480
    ds_read_b64_tr_b16 a[132:133], v62 offset:24576
    ds_read_b64_tr_b16 a[134:135], v63 offset:24576
    ds_read_b64_tr_b16 a[136:137], v62 offset:28672
    ds_read_b64_tr_b16 a[138:139], v63 offset:28672
    ds_read_b64_tr_b16 a[140:141], v4 offset:0
    ds_read_b64_tr_b16 a[142:143], v50 offset:0
    ds_read_b64_tr_b16 a[144:145], v4 offset:4096
    ds_read_b64_tr_b16 a[146:147], v50 offset:4096
    ds_read_b64_tr_b16 a[148:149], v4 offset:8192
    ds_read_b64_tr_b16 a[150:151], v50 offset:8192
    ds_read_b64_tr_b16 a[152:153], v4 offset:12288
    ds_read_b64_tr_b16 a[154:155], v50 offset:12288
    ds_read_b64_tr_b16 a[156:157], v4 offset:16384
    ds_read_b64_tr_b16 a[158:159], v50 offset:16384
    ds_read_b64_tr_b16 a[160:161], v4 offset:20480
    ds_read_b64_tr_b16 a[162:163], v50 offset:20480
    ds_read_b64_tr_b16 a[164:165], v4 offset:24576
    ds_read_b64_tr_b16 a[166:167], v50 offset:24576
    ds_read_b64_tr_b16 a[168:169], v4 offset:28672
    ds_read_b64_tr_b16 a[170:171], v50 offset:28672
    ds_read_b64_tr_b16 a[172:173], v4 offset:32768
    ds_read_b64_tr_b16 a[174:175], v50 offset:32768
    ds_read_b64_tr_b16 a[176:177], v4 offset:36864
    ds_read_b64_tr_b16 a[178:179], v50 offset:36864
    ds_read_b64_tr_b16 a[180:181], v4 offset:40960
    ds_read_b64_tr_b16 a[182:183], v50 offset:40960
    ds_read_b64_tr_b16 a[184:185], v4 offset:45056
    ds_read_b64_tr_b16 a[186:187], v50 offset:45056
    ds_read_b64_tr_b16 a[188:189], v4 offset:49152
    ds_read_b64_tr_b16 a[190:191], v50 offset:49152
    ds_read_b64_tr_b16 a[192:193], v4 offset:53248
    ds_read_b64_tr_b16 a[194:195], v50 offset:53248
    s_waitcnt vmcnt(15)
    v_accvgpr_mov_b32 a68, a36
    v_accvgpr_mov_b32 a69, a37
    s_waitcnt vmcnt(13)
    v_mfma_f32_32x32x16_bf16 v[80:95], a[38:41], v[14:17], v[80:95]
    s_waitcnt vmcnt(11)
    v_mfma_f32_32x32x16_bf16 v[64:79], a[42:45], v[16:19], v[64:79]
    s_waitcnt vmcnt(9)
    v_mfma_f32_32x32x16_bf16 v[80:95], a[46:49], v[14:17], v[80:95]
    s_waitcnt vmcnt(6)
    v_mfma_f32_32x32x16_bf16 v[64:79], a[50:53], v[16:19], v[64:79]
    s_waitcnt vmcnt(5)
    v_mfma_f32_32x32x16_bf16 v[80:95], a[54:57], v[14:17], v[80:95]
    s_waitcnt vmcnt(4)
    v_mfma_f32_32x32x16_bf16 v[64:79], a[58:61], v[16:19], v[64:79]
    s_waitcnt vmcnt(3)
    v_mfma_f32_32x32x16_bf16 v[80:95], a[62:65], v[14:17], v[80:95]
    v_mfma_f32_32x32x16_bf16 v[64:79], a[66:69], v[16:19], v[64:79]
    buffer_load_dwordx4 a[84:87], v26, s[20:23], s60 offen offset:3072 sc1
    s_cmp_ge_u32 s93, 44
    s_cbranch_scc1 Lth20
    s_waitcnt vmcnt(3)
Lth20:
    s_xor_b32 s60, s66, 35676160
    buffer_load_dwordx4 a[88:91], v26, s[20:23], s60 offen offset:0 sc1
    s_cmp_ge_u32 s93, 44
    s_cbranch_scc1 Lth21
    s_waitcnt vmcnt(3)
Lth21:
    buffer_load_dwordx4 a[92:95], v26, s[20:23], s60 offen offset:1024 sc1
    s_cmp_ge_u32 s93, 44
    s_cbranch_scc1 Lth22
    s_waitcnt vmcnt(3)
Lth22:
    buffer_load_dwordx4 a[96:99], v26, s[20:23], s60 offen offset:2048 sc1
    s_cmp_ge_u32 s93, 44
    s_cbranch_scc1 Lth23
    s_waitcnt vmcnt(3)
Lth23:
    buffer_load_dwordx4 a[100:103], v26, s[20:23], s60 offen offset:3072 sc1
    s_waitcnt vmcnt(7)
    v_accvgpr_mov_b32 a104, a72
    v_accvgpr_mov_b32 a105, a73
    s_waitcnt vmcnt(6)
    v_mfma_f32_32x32x16_bf16 v[80:95], a[74:77], v[20:23], v[80:95]
    s_waitcnt vmcnt(5)
    v_mfma_f32_32x32x16_bf16 v[64:79], a[78:81], v[22:25], v[64:79]
    s_waitcnt vmcnt(4)
    v_mfma_f32_32x32x16_bf16 v[80:95], a[82:85], v[20:23], v[80:95]
    s_waitcnt vmcnt(3)
    v_mfma_f32_32x32x16_bf16 v[64:79], a[86:89], v[22:25], v[64:79]
    s_waitcnt vmcnt(2)
    v_mfma_f32_32x32x16_bf16 v[80:95], a[90:93], v[20:23], v[80:95]
    s_waitcnt vmcnt(1)
    v_mfma_f32_32x32x16_bf16 v[64:79], a[94:97], v[22:25], v[64:79]
    s_waitcnt vmcnt(0)
    v_mfma_f32_32x32x16_bf16 v[80:95], a[98:101], v[20:23], v[80:95]
    v_mfma_f32_32x32x16_bf16 v[64:79], a[102:105], v[22:25], v[64:79]
    s_lshl_b32 s52, s46, 14
    s_add_u32 s60, s47, s52
    s_nop 8
    v_pk_mul_f32 v[32:33], v[80:81], v[40:41]
    v_pk_mul_f32 v[34:35], v[82:83], v[40:41]
    v_exp_f32 v80, -|v80|
    v_exp_f32 v81, -|v81|
    v_exp_f32 v82, -|v82|
    v_exp_f32 v83, -|v83|
    v_exp_f32 v88, v88
    v_fma_f32 v36, -v32, v32, |v32|
    v_exp_f32 v89, v89
    v_fma_f32 v37, -v33, v33, |v33|
    v_exp_f32 v90, v90
    v_fma_f32 v38, -v34, v34, |v34|
    v_exp_f32_e64 v91, v91
    v_fma_f32 v39, -v35, v35, |v35|
    v_pk_fma_f32 v[104:105], v[80:81], v[80:81], v[28:29] neg_lo:[1,0,0] neg_hi:[1,0,0]
    v_pk_fma_f32 v[80:81], v[80:81], v[80:81], v[28:29]
    v_pk_fma_f32 v[106:107], v[82:83], v[82:83], v[28:29] neg_lo:[1,0,0] neg_hi:[1,0,0]
    v_pk_fma_f32 v[82:83], v[82:83], v[82:83], v[28:29]
    v_pk_fma_f32 v[80:81], v[80:81], v[88:89], v[80:81]
    v_pk_fma_f32 v[82:83], v[82:83], v[90:91], v[82:83]
    v_rcp_f32 v80, v80
    v_med3_f32 v104, v104, v36, |v32|
    v_rcp_f32 v81, v81
    v_med3_f32 v105, v105, v37, |v33|
    v_rcp_f32_e64 v82, v82
    v_med3_f32 v106, v106, v38, |v34|
    v_rcp_f32_e64 v83, v83
    v_med3_f32 v107, v107, v39, |v35|
    v_bfi_b32 v104, s69, v104, v32
    v_bfi_b32 v105, s69, v105, v33
    v_bfi_b32 v106, s69, v106, v34
    v_bfi_b32 v107, s69, v107, v35
    v_pk_mul_f32 v[104:105], v[104:105], v[80:81]
    v_pk_mul_f32 v[106:107], v[106:107], v[82:83]
    v_cvt_pk_bf16_f32 v114, v104, v105
    v_cvt_pk_bf16_f32 v115, v106, v107
    v_pk_mul_f32 v[32:33], v[64:65], v[40:41]
    v_pk_mul_f32 v[34:35], v[66:67], v[40:41]
    v_exp_f32 v64, -|v64|
    v_exp_f32 v65, -|v65|
    v_exp_f32 v66, -|v66|
    v_exp_f32 v67, -|v67|
    v_exp_f32 v72, v72
    v_fma_f32 v36, -v32, v32, |v32|
    v_exp_f32 v73, v73
    v_fma_f32 v37, -v33, v33, |v33|
    v_exp_f32 v74, v74
    v_fma_f32 v38, -v34, v34, |v34|
    v_exp_f32 v75, v75
    v_fma_f32 v39, -v35, v35, |v35|
    v_pk_fma_f32 v[96:97], v[64:65], v[64:65], v[28:29] neg_lo:[1,0,0] neg_hi:[1,0,0]
    v_pk_fma_f32 v[64:65], v[64:65], v[64:65], v[28:29]
    v_pk_fma_f32 v[98:99], v[66:67], v[66:67], v[28:29] neg_lo:[1,0,0] neg_hi:[1,0,0]
    v_pk_fma_f32 v[66:67], v[66:67], v[66:67], v[28:29]
    v_pk_fma_f32 v[64:65], v[64:65], v[72:73], v[64:65]
    v_pk_fma_f32 v[66:67], v[66:67], v[74:75], v[66:67]
    v_rcp_f32 v64, v64
    v_med3_f32 v96, v96, v36, |v32|
    v_rcp_f32 v65, v65
    v_med3_f32 v97, v97, v37, |v33|
    v_rcp_f32 v66, v66
    v_med3_f32 v98, v98, v38, |v34|
    v_rcp_f32 v67, v67
    v_med3_f32 v99, v99, v39, |v35|
    v_bfi_b32 v96, s69, v96, v32
    v_bfi_b32 v97, s69, v97, v33
    v_bfi_b32 v98, s69, v98, v34
    v_bfi_b32 v99, s69, v99, v35
    v_pk_mul_f32 v[96:97], v[96:97], v[64:65]
    v_pk_mul_f32 v[98:99], v[98:99], v[66:67]
    v_cvt_pk_bf16_f32 v112, v96, v97
    v_cvt_pk_bf16_f32 v113, v98, v99
    buffer_store_dwordx4 v[112:115], v6, s[20:23], s60 offen offset:0 sc0 sc1
    ds_write_b128 v52, v[112:115] offset:0
    v_pk_mul_f32 v[32:33], v[84:85], v[40:41]
    v_pk_mul_f32 v[34:35], v[86:87], v[40:41]
    v_exp_f32 v84, -|v84|
    v_exp_f32 v85, -|v85|
    v_exp_f32 v86, -|v86|
    v_exp_f32 v87, -|v87|
    v_exp_f32_e64 v92, v92
    v_fma_f32 v36, -v32, v32, |v32|
    v_exp_f32 v93, v93
    v_fma_f32 v37, -v33, v33, |v33|
    v_exp_f32 v94, v94
    v_fma_f32 v38, -v34, v34, |v34|
    v_exp_f32_e64 v95, v95
    v_fma_f32 v39, -v35, v35, |v35|
    v_pk_fma_f32 v[108:109], v[84:85], v[84:85], v[28:29] neg_lo:[1,0,0] neg_hi:[1,0,0]
    v_pk_fma_f32 v[84:85], v[84:85], v[84:85], v[28:29]
    v_pk_fma_f32 v[110:111], v[86:87], v[86:87], v[28:29] neg_lo:[1,0,0] neg_hi:[1,0,0]
    v_pk_fma_f32 v[86:87], v[86:87], v[86:87], v[28:29]
    v_pk_fma_f32 v[84:85], v[84:85], v[92:93], v[84:85]
    v_pk_fma_f32 v[86:87], v[86:87], v[94:95], v[86:87]
    v_rcp_f32 v84, v84
    v_med3_f32 v108, v108, v36, |v32|
    v_rcp_f32 v85, v85
    v_med3_f32 v109, v109, v37, |v33|
    v_rcp_f32_e64 v86, v86
    v_med3_f32 v110, v110, v38, |v34|
    v_rcp_f32_e64 v87, v87
    v_med3_f32 v111, v111, v39, |v35|
    v_bfi_b32 v108, s69, v108, v32
    v_bfi_b32 v109, s69, v109, v33
    v_bfi_b32 v110, s69, v110, v34
    v_bfi_b32 v111, s69, v111, v35
    v_pk_mul_f32 v[108:109], v[108:109], v[84:85]
    v_pk_mul_f32 v[110:111], v[110:111], v[86:87]
    v_cvt_pk_bf16_f32 v118, v108, v109
    v_cvt_pk_bf16_f32 v119, v110, v111
    v_pk_mul_f32 v[32:33], v[68:69], v[40:41]
    v_pk_mul_f32 v[34:35], v[70:71], v[40:41]
    v_exp_f32 v68, -|v68|
    v_exp_f32 v69, -|v69|
    v_exp_f32 v70, -|v70|
    v_exp_f32 v71, -|v71|
    v_exp_f32 v76, v76
    v_fma_f32 v36, -v32, v32, |v32|
    v_exp_f32 v77, v77
    v_fma_f32 v37, -v33, v33, |v33|
    v_exp_f32 v78, v78
    v_fma_f32 v38, -v34, v34, |v34|
    v_exp_f32 v79, v79
    v_fma_f32 v39, -v35, v35, |v35|
    v_pk_fma_f32 v[100:101], v[68:69], v[68:69], v[28:29] neg_lo:[1,0,0] neg_hi:[1,0,0]
    v_pk_fma_f32 v[68:69], v[68:69], v[68:69], v[28:29]
    v_pk_fma_f32 v[102:103], v[70:71], v[70:71], v[28:29] neg_lo:[1,0,0] neg_hi:[1,0,0]
    v_pk_fma_f32 v[70:71], v[70:71], v[70:71], v[28:29]
    v_pk_fma_f32 v[68:69], v[68:69], v[76:77], v[68:69]
    v_pk_fma_f32 v[70:71], v[70:71], v[78:79], v[70:71]
    v_rcp_f32 v68, v68
    v_med3_f32 v100, v100, v36, |v32|
    v_rcp_f32 v69, v69
    v_med3_f32 v101, v101, v37, |v33|
    v_rcp_f32_e64 v70, v70
    v_med3_f32 v102, v102, v38, |v34|
    v_rcp_f32_e64 v71, v71
    v_med3_f32 v103, v103, v39, |v35|
    v_bfi_b32 v100, s69, v100, v32
    v_bfi_b32 v101, s69, v101, v33
    v_bfi_b32 v102, s69, v102, v34
    v_bfi_b32 v103, s69, v103, v35
    v_pk_mul_f32 v[100:101], v[100:101], v[68:69]
    v_pk_mul_f32 v[102:103], v[102:103], v[70:71]
    v_cvt_pk_bf16_f32 v116, v100, v101
    v_cvt_pk_bf16_f32 v117, v102, v103
    buffer_store_dwordx4 v[116:119], v6, s[20:23], s60 offen offset:1024 sc0 sc1
    ds_write_b128 v52, v[116:119] offset:1024
    s_lshl_b32 s52, s46, 15
    s_add_u32 s52, s52, s54
    v_mov_b32_e64 v60, 64
    s_mov_b32 s59, s54
    s_add_u32 m0, s65, 57344
    s_add_u32 s100, s50, 98304
    buffer_load_dwordx4 v3, s[32:35], s100 offen lds
    s_add_u32 m0, s65, 61440
    s_add_u32 s100, s50, 114688
    buffer_load_dwordx4 v3, s[32:35], s100 offen lds
    s_add_u32 m0, s65, 65536
    s_add_u32 s100, s51, 0
    buffer_load_dwordx4 v3, s[32:35], s100 offen lds
    s_add_u32 m0, s65, 69632
    s_add_u32 s100, s51, 16384
    buffer_load_dwordx4 v3, s[32:35], s100 offen lds
    s_add_u32 m0, s65, 73728
    s_add_u32 s100, s51, 32768
    buffer_load_dwordx4 v3, s[32:35], s100 offen lds
    s_add_u32 m0, s65, 77824
    s_add_u32 s100, s51, 49152
    buffer_load_dwordx4 v3, s[32:35], s100 offen lds
    s_waitcnt vmcnt(6) lgkmcnt(0)
    s_barrier
    s_cmp_lg_u32 s40, 0
    s_cbranch_scc1 Lzf
    buffer_store_dword v60, v31, s[20:23], s52 offen sc0 sc1
Lzf:
    s_add_u32 m0, s65, 81920
    s_add_u32 s100, s51, 65536
    buffer_load_dwordx4 v3, s[32:35], s100 offen lds
    s_add_u32 m0, s65, 86016
    s_add_u32 s100, s51, 81920
    buffer_load_dwordx4 v3, s[32:35], s100 offen lds
    s_add_u32 m0, s65, 90112
    s_add_u32 s100, s51, 98304
    buffer_load_dwordx4 v3, s[32:35], s100 offen lds
    s_add_u32 m0, s65, 94208
    s_add_u32 s100, s51, 114688
    buffer_load_dwordx4 v3, s[32:35], s100 offen lds
    ds_read_b128 v[128:131], v53 offset:0
    ds_read_b128 v[132:135], v53 offset:1024
    ds_read_b128 v[136:139], v53 offset:2048
    ds_read_b128 v[140:143], v53 offset:3072
    ds_read_b128 v[144:147], v53 offset:4096
    ds_read_b128 v[148:151], v53 offset:5120
    ds_read_b128 v[152:155], v53 offset:6144
    ds_read_b128 v[156:159], v53 offset:7168
    s_waitcnt lgkmcnt(7)
    v_mfma_f32_32x32x16_bf16 v[240:255], a[108:111], v[128:131], 0
    s_waitcnt lgkmcnt(6)
    v_mfma_f32_32x32x16_bf16 v[240:255], a[112:115], v[132:135], v[240:255]
    s_waitcnt lgkmcnt(5)
    v_mfma_f32_32x32x16_bf16 v[240:255], a[116:119], v[136:139], v[240:255]
    s_waitcnt lgkmcnt(4)
    v_mfma_f32_32x32x16_bf16 v[240:255], a[120:123], v[140:143], v[240:255]
    s_waitcnt lgkmcnt(3)
    v_mfma_f32_32x32x16_bf16 v[240:255], a[124:127], v[144:147], v[240:255]
    s_waitcnt lgkmcnt(2)
    v_mfma_f32_32x32x16_bf16 v[240:255], a[128:131], v[148:151], v[240:255]
    s_waitcnt lgkmcnt(1)
    v_mfma_f32_32x32x16_bf16 v[240:255], a[132:135], v[152:155], v[240:255]
    s_waitcnt lgkmcnt(0)
    v_mfma_f32_32x32x16_bf16 v[240:255], a[136:139], v[156:159], v[240:255]
    s_add_u32 s53, s46, 1
    s_and_b32 s53, s53, 3
    s_lshl_b32 s53, s53, 14
    s_add_u32 s49, s47, s53
    s_add_u32 s53, s46, 2
    s_and_b32 s53, s53, 3
    s_lshl_b32 s53, s53, 14
    s_add_u32 s50, s47, s53
    s_add_u32 s53, s46, 3
    s_and_b32 s53, s53, 3
    s_lshl_b32 s53, s53, 14
    s_add_u32 s51, s47, s53
    s_waitcnt vmcnt(0)
    s_cmp_lg_u32 s40, 1
    s_cbranch_scc1 Lgo3
    v_mov_b32 v61, 0
    s_mov_b32 s53, 0
Lchk3:
    v_cmp_gt_u32 vcc, 64, v61
    s_add_u32 s53, s53, 1
    s_cmp_ge_u32 s53, 0x200000
    s_cbranch_scc1 Lgo3
    s_nop 1
    s_cbranch_vccz Lgo3
    buffer_load_dword v61, v30, s[20:23], s59 offen sc1
    s_waitcnt vmcnt(0)
    s_branch Lchk3
Lgo3:
    s_barrier
    s_lshl_b32 s52, s40, 11
    s_add_u32 m0, s52, 106496
    s_nop 0
    buffer_load_dwordx4 v6, s[20:23], s49 offen offset:0 sc1 lds
    buffer_load_dwordx4 v6, s[20:23], s49 offen offset:1024 sc1 lds
    s_add_u32 m0, s52, 114688
    s_nop 0
    buffer_load_dwordx4 v6, s[20:23], s50 offen offset:0 sc1 lds
    buffer_load_dwordx4 v6, s[20:23], s50 offen offset:1024 sc1 lds
    s_add_u32 m0, s52, 122880
    s_nop 0
    buffer_load_dwordx4 v6, s[20:23], s51 offen offset:0 sc1 lds
    buffer_load_dwordx4 v6, s[20:23], s51 offen offset:1024 sc1 lds
    ds_read_b64_tr_b16 a[196:197], v4 offset:57344
    ds_read_b64_tr_b16 a[198:199], v50 offset:57344
    ds_read_b64_tr_b16 a[200:201], v4 offset:61440
    ds_read_b64_tr_b16 a[202:203], v50 offset:61440
    ds_read_b64_tr_b16 a[204:205], v5 offset:0
    ds_read_b64_tr_b16 a[206:207], v51 offset:0
    ds_read_b64_tr_b16 a[208:209], v5 offset:4096
    ds_read_b64_tr_b16 a[210:211], v51 offset:4096
    ds_read_b64_tr_b16 a[212:213], v5 offset:8192
    ds_read_b64_tr_b16 a[214:215], v51 offset:8192
    ds_read_b64_tr_b16 a[216:217], v5 offset:12288
    ds_read_b64_tr_b16 a[218:219], v51 offset:12288
    ds_read_b64_tr_b16 a[220:221], v5 offset:16384
    ds_read_b64_tr_b16 a[222:223], v51 offset:16384
Lpg7:
    s_cbranch_execz Lback
    ds_read_b64_tr_b16 a[224:225], v5 offset:20480
    ds_read_b64_tr_b16 a[226:227], v51 offset:20480
    ds_read_b64_tr_b16 a[228:229], v5 offset:24576
    ds_read_b64_tr_b16 a[230:231], v51 offset:24576
    ds_read_b64_tr_b16 a[232:233], v5 offset:28672
    ds_read_b64_tr_b16 a[234:235], v51 offset:28672
    s_waitcnt vmcnt(4)
    s_barrier
    ds_read_b128 v[128:131], v53 offset:8192
    ds_read_b128 v[132:135], v53 offset:9216
    ds_read_b128 v[136:139], v53 offset:10240
    ds_read_b128 v[140:143], v53 offset:11264
    s_waitcnt lgkmcnt(3)
    v_mfma_f32_32x32x16_bf16 v[240:255], a[140:143], v[128:131], v[240:255]
    ds_read_b128 v[144:147], v53 offset:12288
    s_waitcnt lgkmcnt(3)
    v_mfma_f32_32x32x16_bf16 v[240:255], a[144:147], v[132:135], v[240:255]
    ds_read_b128 v[148:151], v53 offset:13312
    s_waitcnt lgkmcnt(3)
    v_mfma_f32_32x32x16_bf16 v[240:255], a[148:151], v[136:139], v[240:255]
    ds_read_b128 v[152:155], v53 offset:14336
    s_waitcnt lgkmcnt(3)
    v_mfma_f32_32x32x16_bf16 v[240:255], a[152:155], v[140:143], v[240:255]
    ds_read_b128 v[156:159], v53 offset:15360
    s_waitcnt lgkmcnt(3)
    v_mfma_f32_32x32x16_bf16 v[240:255], a[156:159], v[144:147], v[240:255]
    s_waitcnt vmcnt(0)
    s_barrier
    ds_read_b128 v[128:131], v53 offset:16384
    s_waitcnt lgkmcnt(3)
    v_mfma_f32_32x32x16_bf16 v[240:255], a[160:163], v[148:151], v[240:255]
    ds_read_b128 v[132:135], v53 offset:17408
    s_waitcnt lgkmcnt(3)
    v_mfma_f32_32x32x16_bf16 v[240:255], a[164:167], v[152:155], v[240:255]
    ds_read_b128 v[136:139], v53 offset:18432
    s_waitcnt lgkmcnt(3)
    v_mfma_f32_32x32x16_bf16 v[240:255], a[168:171], v[156:159], v[240:255]
    ds_read_b128 v[140:143], v53 offset:19456
    s_waitcnt lgkmcnt(3)
    v_mfma_f32_32x32x16_bf16 v[240:255], a[172:175], v[128:131], v[240:255]
    ds_read_b128 v[144:147], v53 offset:20480
    s_waitcnt lgkmcnt(3)
    v_mfma_f32_32x32x16_bf16 v[240:255], a[176:179], v[132:135], v[240:255]
    ds_read_b128 v[148:151], v53 offset:21504
    s_waitcnt lgkmcnt(3)
    v_mfma_f32_32x32x16_bf16 v[240:255], a[180:183], v[136:139], v[240:255]
    ds_read_b128 v[152:155], v53 offset:22528
    s_waitcnt lgkmcnt(3)
    v_mfma_f32_32x32x16_bf16 v[240:255], a[184:187], v[140:143], v[240:255]
    ds_read_b128 v[156:159], v53 offset:23552
    s_waitcnt lgkmcnt(3)
    v_mfma_f32_32x32x16_bf16 v[240:255], a[188:191], v[144:147], v[240:255]
    ds_read_b128 v[128:131], v53 offset:24576
    s_waitcnt lgkmcnt(3)
    v_mfma_f32_32x32x16_bf16 v[240:255], a[192:195], v[148:151], v[240:255]
    ds_read_b128 v[132:135], v53 offset:25600
    s_waitcnt lgkmcnt(3)
    v_mfma_f32_32x32x16_bf16 v[240:255], a[196:199], v[152:155], v[240:255]
    ds_read_b128 v[136:139], v53 offset:26624
    s_waitcnt lgkmcnt(3)
    v_mfma_f32_32x32x16_bf16 v[240:255], a[200:203], v[156:159], v[240:255]
    ds_read_b128 v[140:143], v53 offset:27648
    s_waitcnt lgkmcnt(3)
    v_mfma_f32_32x32x16_bf16 v[240:255], a[204:207], v[128:131], v[240:255]
    ds_read_b128 v[144:147], v53 offset:28672
    s_waitcnt lgkmcnt(3)
    v_mfma_f32_32x32x16_bf16 v[240:255], a[208:211], v[132:135], v[240:255]
    ds_read_b128 v[148:151], v53 offset:29696
    s_waitcnt lgkmcnt(3)
    v_mfma_f32_32x32x16_bf16 v[240:255], a[212:215], v[136:139], v[240:255]
    ds_read_b128 v[152:155], v53 offset:30720
    s_waitcnt lgkmcnt(3)
    v_mfma_f32_32x32x16_bf16 v[240:255], a[216:219], v[140:143], v[240:255]
    ds_read_b128 v[156:159], v53 offset:31744
    s_waitcnt lgkmcnt(3)
    v_mfma_f32_32x32x16_bf16 v[240:255], a[220:223], v[144:147], v[240:255]
    s_waitcnt lgkmcnt(2)
    v_mfma_f32_32x32x16_bf16 v[240:255], a[224:227], v[148:151], v[240:255]
    s_waitcnt lgkmcnt(1)
    v_mfma_f32_32x32x16_bf16 v[240:255], a[228:231], v[152:155], v[240:255]
    s_waitcnt lgkmcnt(0)
    v_mfma_f32_32x32x16_bf16 v[240:255], a[232:235], v[156:159], v[240:255]
    s_nop 7
    s_nop 3
    v_cvt_pk_bf16_f32 v224, v240, v241
    v_cvt_pk_bf16_f32 v225, v242, v243
    v_cvt_pk_bf16_f32 v226, v244, v245
    v_cvt_pk_bf16_f32 v227, v246, v247
    ds_write_b128 v54, v[224:227]
    v_cvt_pk_bf16_f32 v228, v248, v249
    v_cvt_pk_bf16_f32 v229, v250, v251
    v_cvt_pk_bf16_f32 v230, v252, v253
    v_cvt_pk_bf16_f32 v231, v254, v255
    ds_write_b128 v55, v[228:231]
    s_waitcnt lgkmcnt(0)
    s_barrier
    ds_read_b128 v[232:235], v56
    ds_read_b128 v[236:239], v57 offset:1024
    s_waitcnt lgkmcnt(1)
    buffer_store_dwordx4 v[232:235], v7, s[36:39], 0 offen
    s_waitcnt lgkmcnt(0)
    buffer_store_dwordx4 v[236:239], v2, s[36:39], 0 offen
Lend:
    s_endpgm
.fill 64, 4, 0xbf810000
.section .rodata,"a"
.p2align 6
.amdhsa_kernel standalone__autoregressive_conv_wavenet__speech_kernel
  .amdhsa_next_free_vgpr 512
  .amdhsa_next_free_sgpr 102
  .amdhsa_accum_offset 256
  .amdhsa_group_segment_fixed_size 0
  .amdhsa_kernarg_size 48
  .amdhsa_user_sgpr_count 2
  .amdhsa_user_sgpr_kernarg_segment_ptr 1
  .amdhsa_system_sgpr_workgroup_id_x 1
.end_amdhsa_kernel
.text
```
